```python
import torch

def _softmax(x, axis=-1):
    return torch.softmax(x, dim=axis)
def _gelu(x):
    return torch.nn.functional.gelu(x, approximate="tanh")
def _silu(x):
    return torch.nn.functional.silu(x)
def _sigmoid(x):
    return torch.sigmoid(x)
def _layernorm(x, axis=-1, eps=1e-5):
    m = x.mean(dim=axis, keepdim=True)
    v = x.var(dim=axis, keepdim=True, unbiased=False)
    return (x - m) / torch.sqrt(v + eps)
def _scatter_add(tgt, idx, src, axis=0):
    return tgt.clone().index_add_(axis, idx, src)
def _segment_sum(src, seg, n):
    out = torch.zeros((n,) + src.shape[1:], dtype=src.dtype)
    return out.index_add_(0, seg, src)
def _pad(x, pw):
    flat = tuple(v for pair in reversed(pw) for v in pair)
    return torch.nn.functional.pad(x, flat)

kernel_name = 'standalone__edge_featured_mpnn_egc__graph'

def setup_inputs():

    _w = (lambda a: (lambda t: t.to(torch.bfloat16) if t.is_floating_point() else t)(torch.as_tensor(a)))
    N, deg, D, De = 12500, 64, 64, max(16, 1)
    E = N * deg
    return {
        "x": _w((lambda *s: torch.randn(*s, dtype=torch.bfloat16) * 0.2)(N, D)),
        "e_attr": _w((lambda *s: torch.randn(*s, dtype=torch.bfloat16) * 0.2)(E, De)),
        "src": _w((lambda lo, hi, *s: torch.randint(lo, hi, s))(0, N, E).to(torch.int64)),
        "dst": _w((lambda lo, hi, *s: torch.randint(lo, hi, s))(0, N, E).to(torch.int64)),
        "u_w": _w((lambda *s: torch.randn(*s, dtype=torch.bfloat16) * 0.05)(D, D)),
        "v_w": _w((lambda *s: torch.randn(*s, dtype=torch.bfloat16) * 0.05)(D, D)),
        "g_w": _w((lambda *s: torch.randn(*s, dtype=torch.bfloat16) * 0.2)(2 * D + De, D)),
    }

def reference(x, e_attr, src, dst, u_w, v_w, g_w):
    N, D = x.shape
    g_in = torch.concatenate([x[dst], x[src], e_attr], axis=-1)
    eta = _sigmoid(g_in @ g_w)
    hv = x @ v_w
    msg = eta * hv[src]
    agg = _segment_sum(msg, dst, N)
    return _silu(x @ u_w + agg)
```

```asm
; @launch kernel=bin_kernel grid=(253,1,1) block=(832,1,1) lds=18432
; @launch kernel=main_kernel grid=(256,1,1) block=(512,1,1) lds=161536
.amdgcn_target "amdgcn-amd-amdhsa--gfx950"
.text
    .globl bin_kernel
    .p2align 8
    .type bin_kernel,@function
bin_kernel:
    s_cmp_ge_u32 s2, 250
    s_cbranch_scc1 L_k1_w
    s_load_dwordx4 s[4:7], s[0:1], 16
    s_load_dwordx2 s[8:9], s[0:1], 72
    v_lshlrev_b32 v3, 4, v0
    s_mul_i32 s3, s2, 12800
    v_cmp_gt_u32 vcc, 800, v0
    v_and_b32 v1, 255, v0
    v_lshlrev_b32 v1, 2, v1
    v_mov_b32 v2, 0
    ds_write_b32 v1, v2
    v_mov_b32 v44, -1
    v_mov_b32 v45, -1
    v_mov_b32 v46, -1
    v_mov_b32 v47, -1
    ds_write_b128 v3, v[44:47] offset:2048
    v_lshlrev_b32 v2, 2, v1
    ds_write_b128 v2, v[44:47] offset:14336
    v_readfirstlane_b32 s28, v0
    s_mov_b32 s34, 0x7c
    s_mov_b32 s14, 3200000
    s_mov_b32 s15, 0x00020000
    s_mov_b32 s18, 3200000
    s_mov_b32 s19, 0x00020000
    s_waitcnt lgkmcnt(0)
    s_mov_b32 s16, s6
    s_and_b32 s17, s7, 0xffff
    s_mov_b32 s12, s4
    s_and_b32 s13, s5, 0xffff
    s_and_saveexec_b64 s[24:25], vcc
    buffer_load_dwordx4 v[4:7], v3, s[16:19], s3 offen
    buffer_load_dwordx4 v[8:11], v3, s[12:15], s3 offen
    s_mov_b32 s20, s8
    s_and_b32 s21, s9, 0xffff
    s_mov_b32 s22, 8388608
    s_mov_b32 s23, 0x00020000
    s_barrier
    v_lshlrev_b32 v12, 2, v0
    v_mov_b32 v13, 1
    s_waitcnt vmcnt(1)
    v_and_b32 v14, 7, v4
    v_lshlrev_b32 v14, 7, v14
    v_lshrrev_b32 v18, 1, v4
    v_and_or_b32 v14, v18, s34, v14
    ds_add_rtn_u32 v18, v14, v13
    v_and_b32 v15, 7, v5
    v_lshlrev_b32 v15, 7, v15
    v_lshrrev_b32 v19, 1, v5
    v_and_or_b32 v15, v19, s34, v15
    ds_add_rtn_u32 v19, v15, v13
    v_and_b32 v16, 7, v6
    v_lshlrev_b32 v16, 7, v16
    v_lshrrev_b32 v20, 1, v6
    v_and_or_b32 v16, v20, s34, v16
    ds_add_rtn_u32 v20, v16, v13
    v_and_b32 v17, 7, v7
    v_lshlrev_b32 v17, 7, v17
    v_lshrrev_b32 v21, 1, v7
    v_and_or_b32 v17, v21, s34, v17
    ds_add_rtn_u32 v21, v17, v13
    v_lshrrev_b32 v4, 8, v4
    v_lshl_or_b32 v4, v4, 26, v12
    v_lshrrev_b32 v5, 8, v5
    v_lshl_or_b32 v5, v5, 26, v12
    v_lshrrev_b32 v6, 8, v6
    v_lshl_or_b32 v6, v6, 26, v12
    v_lshrrev_b32 v7, 8, v7
    v_lshl_or_b32 v7, v7, 26, v12
    s_waitcnt vmcnt(0)
    v_lshl_or_b32 v8, v8, 12, 0
    v_or_b32 v4, v4, v8
    v_lshl_or_b32 v9, v9, 12, 1
    v_or_b32 v5, v5, v9
    v_lshl_or_b32 v10, v10, 12, 2
    v_or_b32 v6, v6, v10
    v_lshl_or_b32 v11, v11, 12, 3
    v_or_b32 v7, v7, v11
    s_waitcnt lgkmcnt(0)
    s_barrier
    s_mov_b64 s[26:27], exec
    s_mov_b64 exec, -1
    v_and_b32 v22, 63, v0
    v_lshlrev_b32 v23, 4, v22
    ds_read_b128 v[24:27], v23
    s_waitcnt lgkmcnt(0)
    v_add_u32 v24, 3, v24
    v_lshrrev_b32 v24, 2, v24
    v_add_u32 v25, 3, v25
    v_lshrrev_b32 v25, 2, v25
    v_add_u32 v26, 3, v26
    v_lshrrev_b32 v26, 2, v26
    v_add_u32 v27, 3, v27
    v_lshrrev_b32 v27, 2, v27
    v_add_u32 v28, v24, v25
    v_add_u32 v29, v28, v26
    v_add_u32 v30, v29, v27
    v_mov_b32 v31, v30
    s_nop 1
    v_add_u32_dpp v31, v31, v31 row_shr:1 row_mask:0xf bank_mask:0xf bound_ctrl:0
    s_nop 1
    v_add_u32_dpp v31, v31, v31 row_shr:2 row_mask:0xf bank_mask:0xf bound_ctrl:0
    s_nop 1
    v_add_u32_dpp v31, v31, v31 row_shr:4 row_mask:0xf bank_mask:0xf bound_ctrl:0
    s_nop 1
    v_add_u32_dpp v31, v31, v31 row_shr:8 row_mask:0xf bank_mask:0xf bound_ctrl:0
    s_nop 1
    v_add_u32_dpp v31, v31, v31 row_bcast:15 row_mask:0xa bank_mask:0xf
    s_nop 1
    v_add_u32_dpp v31, v31, v31 row_bcast:31 row_mask:0xc bank_mask:0xf
    v_sub_u32 v32, v31, v30
    v_add_u32 v33, v32, v24
    v_add_u32 v34, v32, v28
    v_add_u32 v35, v32, v29
    v_readlane_b32 s33, v31, 63
    ds_write_b128 v23, v[32:35] offset:1024
    s_cmp_ge_u32 s28, 64
    s_cbranch_scc1 L_k1_nooff
    v_lshl_or_b32 v36, v24, 16, v32
    v_lshl_or_b32 v37, v25, 16, v33
    v_lshl_or_b32 v38, v26, 16, v34
    v_lshl_or_b32 v39, v27, 16, v35
    s_lshl_b32 s32, s2, 10
    s_add_u32 s32, s32, 4194304
    buffer_store_dwordx4 v[36:39], v23, s[20:23], s32 offen
L_k1_nooff:
    s_waitcnt lgkmcnt(0)
    s_mov_b64 exec, s[26:27]
    ds_read_b32 v40, v14 offset:1024
    ds_read_b32 v41, v15 offset:1024
    ds_read_b32 v42, v16 offset:1024
    ds_read_b32 v43, v17 offset:1024
    v_lshlrev_b32 v18, 2, v18
    v_lshlrev_b32 v19, 2, v19
    v_lshlrev_b32 v20, 2, v20
    v_lshlrev_b32 v21, 2, v21
    s_waitcnt lgkmcnt(3)
    v_lshl_add_u32 v40, v40, 4, v18
    s_waitcnt lgkmcnt(2)
    v_lshl_add_u32 v41, v41, 4, v19
    s_waitcnt lgkmcnt(1)
    v_lshl_add_u32 v42, v42, 4, v20
    s_waitcnt lgkmcnt(0)
    v_lshl_add_u32 v43, v43, 4, v21
    ds_write_b32 v40, v4 offset:2048
    ds_write_b32 v41, v5 offset:2048
    ds_write_b32 v42, v6 offset:2048
    ds_write_b32 v43, v7 offset:2048
    s_mov_b64 exec, -1
    s_lshl_b32 s3, s2, 14
    v_add_u32 v2, 832, v0
    s_waitcnt lgkmcnt(0)
    s_barrier
    ds_read_b128 v[44:47], v3 offset:2048
    ds_read_b128 v[36:39], v3 offset:15360
    v_cmp_gt_u32 vcc, s33, v2
    s_add_u32 s32, s3, 13312
    s_waitcnt lgkmcnt(1)
    buffer_store_dwordx4 v[44:47], v3, s[20:23], s3 offen
    s_and_saveexec_b64 s[24:25], vcc
    s_cbranch_execz L_k1_e
    s_waitcnt lgkmcnt(0)
    buffer_store_dwordx4 v[36:39], v3, s[20:23], s32 offen
L_k1_e:
    s_mov_b64 exec, -1
    s_endpgm
L_k1_w:
    s_cmp_ge_u32 s2, 253
    s_cbranch_scc1 L_k1_end
    s_load_dwordx4 s[4:7], s[0:1], 32
    s_load_dwordx2 s[8:9], s[0:1], 48
    s_load_dwordx2 s[10:11], s[0:1], 72
    v_lshrrev_b32 v1, 6, v0
    s_nop 0
    v_readfirstlane_b32 s28, v1
    s_sub_u32 s3, s2, 250
    s_mul_i32 s3, s3, 13
    s_add_u32 s28, s28, s3
    s_cmp_ge_u32 s28, 34
    s_cbranch_scc1 L_k1_end
    s_waitcnt lgkmcnt(0)
    s_mov_b32 s12, s8
    s_mov_b32 s13, s9
    s_mov_b32 s14, 18432
    s_mov_b32 s33, 0xbfb8aa3b
    s_cmp_ge_u32 s28, 5
    s_cselect_b32 s30, 1, 0
    s_mul_i32 s31, s30, 5
    s_sub_u32 s31, s28, s31
    s_add_u32 s31, s31, 4
    s_cmp_lt_u32 s28, 10
    s_cbranch_scc1 L_k1_wgo
    s_mov_b32 s33, 1.0
    s_sub_u32 s29, s28, 10
    s_and_b32 s31, s29, 3
    s_lshr_b32 s30, s29, 2
    s_and_b32 s30, s30, 1
    s_cmp_ge_u32 s28, 18
    s_cbranch_scc1 L_k1_w2
    s_mov_b32 s12, s6
    s_mov_b32 s13, s7
    s_mov_b32 s14, 8192
    s_branch L_k1_wgo
L_k1_w2:
    s_cmp_lt_u32 s28, 26
    s_cbranch_scc1 L_k1_wgo
    s_mov_b32 s12, s4
    s_mov_b32 s13, s5
    s_mov_b32 s14, 8192
L_k1_wgo:
    s_and_b32 s13, s13, 0xffff
    s_mov_b32 s15, 0x00020000
    s_mov_b32 s20, s10
    s_and_b32 s21, s11, 0xffff
    s_mov_b32 s22, 8388608
    s_mov_b32 s23, 0x00020000
    s_lshl_b32 s31, s31, 11
    s_lshl_b32 s30, s30, 6
    s_add_u32 s31, s31, s30
    v_and_b32 v1, 63, v0
    v_lshrrev_b32 v2, 5, v1
    v_lshlrev_b32 v2, 10, v2
    v_and_b32 v3, 31, v0
    v_lshl_add_u32 v2, v3, 1, v2
    buffer_load_ushort v4, v2, s[12:15], s31 offen offset:0
    buffer_load_ushort v5, v2, s[12:15], s31 offen offset:128
    buffer_load_ushort v6, v2, s[12:15], s31 offen offset:256
    buffer_load_ushort v7, v2, s[12:15], s31 offen offset:384
    buffer_load_ushort v8, v2, s[12:15], s31 offen offset:512
    buffer_load_ushort v9, v2, s[12:15], s31 offen offset:640
    buffer_load_ushort v10, v2, s[12:15], s31 offen offset:768
    buffer_load_ushort v11, v2, s[12:15], s31 offen offset:896
    v_lshlrev_b32 v1, 4, v1
    s_lshl_b32 s32, s28, 10
    s_add_u32 s32, s32, 4456448
    s_waitcnt vmcnt(0)
    v_lshlrev_b32 v4, 16, v4
    v_mul_f32 v4, s33, v4
    v_lshlrev_b32 v5, 16, v5
    v_mul_f32 v5, s33, v5
    v_lshlrev_b32 v6, 16, v6
    v_mul_f32 v6, s33, v6
    v_lshlrev_b32 v7, 16, v7
    v_mul_f32 v7, s33, v7
    v_lshlrev_b32 v8, 16, v8
    v_mul_f32 v8, s33, v8
    v_lshlrev_b32 v9, 16, v9
    v_mul_f32 v9, s33, v9
    v_lshlrev_b32 v10, 16, v10
    v_mul_f32 v10, s33, v10
    v_lshlrev_b32 v11, 16, v11
    v_mul_f32 v11, s33, v11
    v_cvt_pk_bf16_f32 v12, v4, v5
    v_cvt_pk_bf16_f32 v13, v6, v7
    v_cvt_pk_bf16_f32 v14, v8, v9
    v_cvt_pk_bf16_f32 v15, v10, v11
    buffer_store_dwordx4 v[12:15], v1, s[20:23], s32 offen
L_k1_end:
    s_endpgm
    .globl main_kernel
    .p2align 8
    .type main_kernel,@function
main_kernel:
    s_cmp_ge_u32 s2, 256
    s_cbranch_scc1 L_k2_end
    s_load_dwordx2 s[10:11], s[0:1], 72
    s_load_dwordx4 s[4:7], s[0:1], 0
    s_load_dwordx2 s[8:9], s[0:1], 56
    v_lshrrev_b32 v16, 6, v0
    v_and_b32 v13, 63, v0
    v_readfirstlane_b32 s28, v16
    v_lshrrev_b32 v247, 1, v0
    v_lshlrev_b32 v16, 10, v247
    s_and_b32 s44, s2, 7
    s_lshl_b32 s44, s44, 5
    s_lshr_b32 s45, s2, 3
    s_add_u32 s44, s44, s45
    s_lshl_b32 s44, s44, 2
    s_mov_b32 s50, 256000
    s_mov_b32 s51, 0x00020000
    v_and_b32 v251, 1, v0
    v_lshlrev_b32 v7, 4, v251
    v_lshl_add_u32 v246, v247, 14, v7
    v_lshrrev_b32 v1, 5, v13
    v_lshlrev_b32 v1, 4, v1
    v_and_b32 v2, 31, v0
    v_lshlrev_b32 v2, 2, v2
    v_lshlrev_b32 v14, 1, v2
    v_lshlrev_b32 v252, 4, v13
    v_lshlrev_b32 v253, 2, v13
    s_waitcnt lgkmcnt(0)
    s_add_u32 s48, s10, 4194304
    s_addc_u32 s49, s11, 0
    s_and_b32 s49, s49, 0xffff
    buffer_load_dword v244, v16, s[48:51], s44 offen
    s_mov_b32 s20, s10
    s_and_b32 s21, s11, 0xffff
    s_mov_b32 s22, 8388608
    s_mov_b32 s23, 0x00020000
    s_mov_b32 s12, s4
    s_and_b32 s13, s5, 0xffff
    s_mov_b32 s14, 1600000
    s_mov_b32 s15, 0x00020000
    s_mov_b32 s16, s6
    s_and_b32 s17, s7, 0xffff
    s_mov_b32 s18, 25600000
    s_mov_b32 s19, 0x00020000
    s_mov_b32 s24, s8
    s_and_b32 s25, s9, 0xffff
    s_mov_b32 s26, 1600000
    s_mov_b32 s27, 0x00020000
    v_mov_b32 v249, 1
    s_mov_b32 s36, 1.0
    s_mov_b32 s37, 1.0
    s_mov_b32 s38, 2097024
    s_mov_b32 s39, 0xfc
    s_mov_b32 s55, 0xfff
    s_mov_b32 s56, 1073741824
    s_mov_b32 s29, 0
    s_mov_b32 s78, 268435456
    v_mov_b32 v241, 0x40000000
    s_mov_b32 s30, 10
    s_mov_b32 s41, 1
    s_mov_b32 s79, 1
    s_mul_i32 s47, s28, 6272
    s_add_u32 s47, s47, 77568
    s_add_u32 s54, s47, 4224
    s_add_u32 s53, s54, 1024
    s_xor_b32 s53, s53, s54
    s_mul_i32 s57, s28, 4224
    s_add_u32 s57, s57, 127744
    v_mov_b32 v242, 0xffffff00
    s_sub_u32 s88, s4, 1056
    s_subb_u32 s89, s5, 0
    s_and_b32 s89, s89, 0xffff
    s_mov_b32 s90, 1601056
    s_mov_b32 s91, 0x00020000
    s_sub_u32 s92, s4, 2112
    s_subb_u32 s93, s5, 0
    s_and_b32 s93, s93, 0xffff
    s_mov_b32 s94, 1602112
    s_mov_b32 s95, 0x00020000
    s_sub_u32 s96, s4, 3168
    s_subb_u32 s97, s5, 0
    s_and_b32 s97, s97, 0xffff
    s_mov_b32 s98, 1603168
    s_mov_b32 s99, 0x00020000
    v_and_b32 v6, 7, v0
    v_lshlrev_b32 v6, 4, v6
    v_xor_b32 v6, v6, v1
    v_and_b32 v18, 25, v0
    v_bfe_u32 v16, v0, 1, 1
    v_lshl_or_b32 v18, v16, 2, v18
    v_bfe_u32 v16, v0, 2, 1
    v_lshl_or_b32 v18, v16, 1, v18
    v_lshl_add_u32 v9, v18, 5, v1
    v_and_b32 v16, 3, v18
    v_mul_u32_u24 v16, 1056, v16
    v_lshrrev_b32 v17, 2, v18
    v_lshl_add_u32 v16, v17, 7, v16
    v_and_b32 v17, 16, v0
    v_xor_b32 v17, v17, v1
    v_add_u32 v8, v16, v17
    v_mov_b32 v16, 0
    v_mov_b32 v17, 3072
    ds_write_b32 v17, v16
    v_mul_u32_u24 v247, 3200, v247
L_k2_init:
    v_mov_b32 v140, 0
    v_lshlrev_b32 v18, 2, v0
    ds_write_b32 v18, v140
    v_mov_b32 v120, 2097024
    v_mov_b32 v121, 2097024
    v_mov_b32 v122, 2097024
    v_mov_b32 v123, 2097024
    v_mov_b32 v124, 33554432
    v_mov_b32 v125, 33554432
    v_mov_b32 v126, 33554432
    v_mov_b32 v127, 33554432
    v_lshlrev_b32 v18, 4, v0
    ds_write_b128 v18, v[120:123] offset:4352
    ds_write_b128 v18, v[120:123] offset:12544
    ds_write_b128 v18, v[120:123] offset:13568
    ds_write_b128 v18, v[124:127] offset:21760
    ds_write_b128 v18, v[124:127] offset:29952
    ds_write_b128 v18, v[124:127] offset:30976
    s_waitcnt lgkmcnt(0)
    s_barrier
    s_cmp_eq_u32 s41, 0
    s_cbranch_scc1 L_k2_round
    s_waitcnt vmcnt(0)
    v_and_b32 v16, 0xffff, v244
    v_lshrrev_b32 v245, 16, v244
    v_lshl_add_u32 v246, v16, 4, v246
L_k2_round:
    s_add_u32 s44, s29, s30
    v_min_u32 v248, s44, v245
    v_subrev_u32 v248, s29, v248
    v_sub_u32 v248, v248, v251
    s_lshl_b32 s45, s29, 4
    v_cmpx_lt_i32 vcc, 0, v248
    s_cbranch_execz L_k2_ld_done
    buffer_load_dwordx4 v[100:103], v246, s[20:23], s45 offen offset:0
    v_cmpx_lt_i32 vcc, 2, v248
    s_cbranch_execz L_k2_ld_done
    buffer_load_dwordx4 v[104:107], v246, s[20:23], s45 offen offset:32
    v_cmpx_lt_i32 vcc, 4, v248
    s_cbranch_execz L_k2_ld_done
    buffer_load_dwordx4 v[108:111], v246, s[20:23], s45 offen offset:64
    v_cmpx_lt_i32 vcc, 6, v248
    s_cbranch_execz L_k2_ld_done
    buffer_load_dwordx4 v[112:115], v246, s[20:23], s45 offen offset:96
    v_cmpx_lt_i32 vcc, 8, v248
    s_cbranch_execz L_k2_ld_done
    buffer_load_dwordx4 v[116:119], v246, s[20:23], s45 offen offset:128
L_k2_ld_done:
    s_mov_b64 exec, -1
    s_cmp_eq_u32 s41, 0
    s_cbranch_scc1 L_k2_now
    s_mov_b32 s41, 0
    s_lshl_b32 s32, s28, 10
    s_add_u32 s45, s32, 4456448
    s_add_u32 s32, s32, 39168
    s_add_u32 m0, s32, 0
    s_add_u32 s46, s45, 0
    buffer_load_dwordx4 v252, s[20:23], s46 offen lds
    s_add_u32 m0, s32, 8192
    s_add_u32 s46, s45, 8192
    buffer_load_dwordx4 v252, s[20:23], s46 offen lds
    s_add_u32 m0, s32, 16384
    s_add_u32 s46, s45, 16384
    buffer_load_dwordx4 v252, s[20:23], s46 offen lds
    s_add_u32 m0, s32, 24576
    s_add_u32 s46, s45, 24576
    buffer_load_dwordx4 v252, s[20:23], s46 offen lds
    s_cmp_ge_u32 s28, 2
    s_cbranch_scc1 L_k2_now0
    s_add_u32 m0, s32, 32768
    s_add_u32 s46, s45, 32768
    buffer_load_dwordx4 v252, s[20:23], s46 offen lds
L_k2_now0:
    s_lshr_b32 s45, s28, 2
    s_lshl_b32 s45, s45, 13
    s_add_u32 s45, s45, s2
    v_lshrrev_b32 v16, 4, v13
    v_lshl_add_u32 v16, v16, 11, s45
    v_bfe_u32 v17, v0, 3, 1
    v_lshl_add_u32 v16, v17, 9, v16
    v_lshlrev_b32 v224, 7, v16
    v_add_u32 v225, 32768, v224
    v_add_u32 v226, 131072, v224
    v_add_u32 v227, 163840, v224
    s_mov_b32 m0, s57
    v_and_or_b32 v12, v224, s38, v6
    buffer_load_dwordx4 v12, s[12:15], 0 offen offset:0 lds
    v_and_or_b32 v12, v225, s38, v6
    buffer_load_dwordx4 v12, s[88:91], 0 offen offset:1056 lds
    v_and_or_b32 v12, v226, s38, v6
    buffer_load_dwordx4 v12, s[92:95], 0 offen offset:2112 lds
    v_and_or_b32 v12, v227, s38, v6
    buffer_load_dwordx4 v12, s[96:99], 0 offen offset:3168 lds
    s_waitcnt vmcnt(4)
    s_branch L_k2_cnt
L_k2_now:
    s_waitcnt vmcnt(0)
L_k2_cnt:
    v_cmpx_lt_u32 vcc, s44, v245
    v_mov_b32 v16, 1280
    ds_write_b32 v16, v249
    s_mov_b64 exec, -1
    v_cmpx_lt_i32 vcc, 0, v248
    s_cbranch_execz L_k2_cnt_done
    v_and_b32_sdwa v120, v100, s39 dst_sel:DWORD dst_unused:UNUSED_PAD src0_sel:BYTE_3 src1_sel:DWORD
    ds_add_rtn_u32 v140, v120, v249 offset:0
    v_and_b32_sdwa v121, v101, s39 dst_sel:DWORD dst_unused:UNUSED_PAD src0_sel:BYTE_3 src1_sel:DWORD
    ds_add_rtn_u32 v141, v121, v249 offset:0
    v_and_b32_sdwa v122, v102, s39 dst_sel:DWORD dst_unused:UNUSED_PAD src0_sel:BYTE_3 src1_sel:DWORD
    ds_add_rtn_u32 v142, v122, v249 offset:0
    v_and_b32_sdwa v123, v103, s39 dst_sel:DWORD dst_unused:UNUSED_PAD src0_sel:BYTE_3 src1_sel:DWORD
    ds_add_rtn_u32 v143, v123, v249 offset:0
    v_lshrrev_b32 v164, 5, v100
    v_and_b32 v165, s55, v100
    v_add_u32 v165, v165, v247
    v_lshrrev_b32 v166, 5, v101
    v_and_b32 v167, s55, v101
    v_add_u32 v167, v167, v247
    v_lshrrev_b32 v168, 5, v102
    v_and_b32 v169, s55, v102
    v_add_u32 v169, v169, v247
    v_lshrrev_b32 v170, 5, v103
    v_and_b32 v171, s55, v103
    v_add_u32 v171, v171, v247
    v_cmp_gt_u32 s[80:81], s78, v100
    v_cmp_gt_u32 s[82:83], s78, v101
    v_cmp_gt_u32 s[84:85], s78, v102
    v_cmp_gt_u32 s[86:87], s78, v103
    v_lshlrev_b32 v16, 5, v165
    v_lshlrev_b32 v17, 5, v167
    v_lshlrev_b32 v18, 5, v169
    v_lshlrev_b32 v19, 5, v171
    v_cndmask_b32 v16, v241, v16, s[80:81]
    buffer_load_dword v254, v16, s[16:19], 0 offen
    v_cndmask_b32 v17, v241, v17, s[82:83]
    buffer_load_dword v254, v17, s[16:19], 0 offen
    v_cndmask_b32 v18, v241, v18, s[84:85]
    buffer_load_dword v254, v18, s[16:19], 0 offen
    v_cndmask_b32 v19, v241, v19, s[86:87]
    buffer_load_dword v254, v19, s[16:19], 0 offen
    v_cmpx_lt_i32 vcc, 2, v248
    s_cbranch_execz L_k2_cnt_done
    v_and_b32_sdwa v124, v104, s39 dst_sel:DWORD dst_unused:UNUSED_PAD src0_sel:BYTE_3 src1_sel:DWORD
    ds_add_rtn_u32 v144, v124, v249 offset:0
    v_and_b32_sdwa v125, v105, s39 dst_sel:DWORD dst_unused:UNUSED_PAD src0_sel:BYTE_3 src1_sel:DWORD
    ds_add_rtn_u32 v145, v125, v249 offset:0
    v_and_b32_sdwa v126, v106, s39 dst_sel:DWORD dst_unused:UNUSED_PAD src0_sel:BYTE_3 src1_sel:DWORD
    ds_add_rtn_u32 v146, v126, v249 offset:0
    v_and_b32_sdwa v127, v107, s39 dst_sel:DWORD dst_unused:UNUSED_PAD src0_sel:BYTE_3 src1_sel:DWORD
    ds_add_rtn_u32 v147, v127, v249 offset:0
    v_lshrrev_b32 v172, 5, v104
    v_and_b32 v173, s55, v104
    v_add_u32 v173, v173, v247
    v_lshrrev_b32 v174, 5, v105
    v_and_b32 v175, s55, v105
    v_add_u32 v175, v175, v247
    v_lshrrev_b32 v176, 5, v106
    v_and_b32 v177, s55, v106
    v_add_u32 v177, v177, v247
    v_lshrrev_b32 v178, 5, v107
    v_and_b32 v179, s55, v107
    v_add_u32 v179, v179, v247
    v_cmp_gt_u32 s[80:81], s78, v104
    v_cmp_gt_u32 s[82:83], s78, v105
    v_cmp_gt_u32 s[84:85], s78, v106
    v_cmp_gt_u32 s[86:87], s78, v107
    v_lshlrev_b32 v16, 5, v173
    v_lshlrev_b32 v17, 5, v175
    v_lshlrev_b32 v18, 5, v177
    v_lshlrev_b32 v19, 5, v179
    v_cndmask_b32 v16, v241, v16, s[80:81]
    buffer_load_dword v254, v16, s[16:19], 0 offen
    v_cndmask_b32 v17, v241, v17, s[82:83]
    buffer_load_dword v254, v17, s[16:19], 0 offen
    v_cndmask_b32 v18, v241, v18, s[84:85]
    buffer_load_dword v254, v18, s[16:19], 0 offen
    v_cndmask_b32 v19, v241, v19, s[86:87]
    buffer_load_dword v254, v19, s[16:19], 0 offen
    v_cmpx_lt_i32 vcc, 4, v248
    s_cbranch_execz L_k2_cnt_done
    v_and_b32_sdwa v128, v108, s39 dst_sel:DWORD dst_unused:UNUSED_PAD src0_sel:BYTE_3 src1_sel:DWORD
    ds_add_rtn_u32 v148, v128, v249 offset:0
    v_and_b32_sdwa v129, v109, s39 dst_sel:DWORD dst_unused:UNUSED_PAD src0_sel:BYTE_3 src1_sel:DWORD
    ds_add_rtn_u32 v149, v129, v249 offset:0
    v_and_b32_sdwa v130, v110, s39 dst_sel:DWORD dst_unused:UNUSED_PAD src0_sel:BYTE_3 src1_sel:DWORD
    ds_add_rtn_u32 v150, v130, v249 offset:0
    v_and_b32_sdwa v131, v111, s39 dst_sel:DWORD dst_unused:UNUSED_PAD src0_sel:BYTE_3 src1_sel:DWORD
    ds_add_rtn_u32 v151, v131, v249 offset:0
    v_lshrrev_b32 v180, 5, v108
    v_and_b32 v181, s55, v108
    v_add_u32 v181, v181, v247
    v_lshrrev_b32 v182, 5, v109
    v_and_b32 v183, s55, v109
    v_add_u32 v183, v183, v247
    v_lshrrev_b32 v184, 5, v110
    v_and_b32 v185, s55, v110
    v_add_u32 v185, v185, v247
    v_lshrrev_b32 v186, 5, v111
    v_and_b32 v187, s55, v111
    v_add_u32 v187, v187, v247
    v_cmp_gt_u32 s[80:81], s78, v108
    v_cmp_gt_u32 s[82:83], s78, v109
    v_cmp_gt_u32 s[84:85], s78, v110
    v_cmp_gt_u32 s[86:87], s78, v111
    v_lshlrev_b32 v16, 5, v181
    v_lshlrev_b32 v17, 5, v183
    v_lshlrev_b32 v18, 5, v185
    v_lshlrev_b32 v19, 5, v187
    v_cndmask_b32 v16, v241, v16, s[80:81]
    buffer_load_dword v254, v16, s[16:19], 0 offen
    v_cndmask_b32 v17, v241, v17, s[82:83]
    buffer_load_dword v254, v17, s[16:19], 0 offen
    v_cndmask_b32 v18, v241, v18, s[84:85]
    buffer_load_dword v254, v18, s[16:19], 0 offen
    v_cndmask_b32 v19, v241, v19, s[86:87]
    buffer_load_dword v254, v19, s[16:19], 0 offen
    v_cmpx_lt_i32 vcc, 6, v248
    s_cbranch_execz L_k2_cnt_done
    v_and_b32_sdwa v132, v112, s39 dst_sel:DWORD dst_unused:UNUSED_PAD src0_sel:BYTE_3 src1_sel:DWORD
    ds_add_rtn_u32 v152, v132, v249 offset:0
    v_and_b32_sdwa v133, v113, s39 dst_sel:DWORD dst_unused:UNUSED_PAD src0_sel:BYTE_3 src1_sel:DWORD
    ds_add_rtn_u32 v153, v133, v249 offset:0
    v_and_b32_sdwa v134, v114, s39 dst_sel:DWORD dst_unused:UNUSED_PAD src0_sel:BYTE_3 src1_sel:DWORD
    ds_add_rtn_u32 v154, v134, v249 offset:0
    v_and_b32_sdwa v135, v115, s39 dst_sel:DWORD dst_unused:UNUSED_PAD src0_sel:BYTE_3 src1_sel:DWORD
    ds_add_rtn_u32 v155, v135, v249 offset:0
    v_lshrrev_b32 v188, 5, v112
    v_and_b32 v189, s55, v112
    v_add_u32 v189, v189, v247
    v_lshrrev_b32 v190, 5, v113
    v_and_b32 v191, s55, v113
    v_add_u32 v191, v191, v247
    v_lshrrev_b32 v192, 5, v114
    v_and_b32 v193, s55, v114
    v_add_u32 v193, v193, v247
    v_lshrrev_b32 v194, 5, v115
    v_and_b32 v195, s55, v115
    v_add_u32 v195, v195, v247
    v_cmp_gt_u32 s[80:81], s78, v112
    v_cmp_gt_u32 s[82:83], s78, v113
    v_cmp_gt_u32 s[84:85], s78, v114
    v_cmp_gt_u32 s[86:87], s78, v115
    v_lshlrev_b32 v16, 5, v189
    v_lshlrev_b32 v17, 5, v191
    v_lshlrev_b32 v18, 5, v193
    v_lshlrev_b32 v19, 5, v195
    v_cndmask_b32 v16, v241, v16, s[80:81]
    buffer_load_dword v254, v16, s[16:19], 0 offen
    v_cndmask_b32 v17, v241, v17, s[82:83]
    buffer_load_dword v254, v17, s[16:19], 0 offen
    v_cndmask_b32 v18, v241, v18, s[84:85]
    buffer_load_dword v254, v18, s[16:19], 0 offen
    v_cndmask_b32 v19, v241, v19, s[86:87]
    buffer_load_dword v254, v19, s[16:19], 0 offen
    v_cmpx_lt_i32 vcc, 8, v248
    s_cbranch_execz L_k2_cnt_done
    v_and_b32_sdwa v136, v116, s39 dst_sel:DWORD dst_unused:UNUSED_PAD src0_sel:BYTE_3 src1_sel:DWORD
    ds_add_rtn_u32 v156, v136, v249 offset:0
    v_and_b32_sdwa v137, v117, s39 dst_sel:DWORD dst_unused:UNUSED_PAD src0_sel:BYTE_3 src1_sel:DWORD
    ds_add_rtn_u32 v157, v137, v249 offset:0
    v_and_b32_sdwa v138, v118, s39 dst_sel:DWORD dst_unused:UNUSED_PAD src0_sel:BYTE_3 src1_sel:DWORD
    ds_add_rtn_u32 v158, v138, v249 offset:0
    v_and_b32_sdwa v139, v119, s39 dst_sel:DWORD dst_unused:UNUSED_PAD src0_sel:BYTE_3 src1_sel:DWORD
    ds_add_rtn_u32 v159, v139, v249 offset:0
    v_lshrrev_b32 v196, 5, v116
    v_and_b32 v197, s55, v116
    v_add_u32 v197, v197, v247
    v_lshrrev_b32 v198, 5, v117
    v_and_b32 v199, s55, v117
    v_add_u32 v199, v199, v247
    v_lshrrev_b32 v200, 5, v118
    v_and_b32 v201, s55, v118
    v_add_u32 v201, v201, v247
    v_lshrrev_b32 v202, 5, v119
    v_and_b32 v203, s55, v119
    v_add_u32 v203, v203, v247
    v_cmp_gt_u32 s[80:81], s78, v116
    v_cmp_gt_u32 s[82:83], s78, v117
    v_cmp_gt_u32 s[84:85], s78, v118
    v_cmp_gt_u32 s[86:87], s78, v119
    v_lshlrev_b32 v16, 5, v197
    v_lshlrev_b32 v17, 5, v199
    v_lshlrev_b32 v18, 5, v201
    v_lshlrev_b32 v19, 5, v203
    v_cndmask_b32 v16, v241, v16, s[80:81]
    buffer_load_dword v254, v16, s[16:19], 0 offen
    v_cndmask_b32 v17, v241, v17, s[82:83]
    buffer_load_dword v254, v17, s[16:19], 0 offen
    v_cndmask_b32 v18, v241, v18, s[84:85]
    buffer_load_dword v254, v18, s[16:19], 0 offen
    v_cndmask_b32 v19, v241, v19, s[86:87]
    buffer_load_dword v254, v19, s[16:19], 0 offen
L_k2_cnt_done:
    s_mov_b64 exec, -1
    v_mov_b32 v18, 1280
    v_cmp_gt_u32 vcc, 49, v13
    s_waitcnt lgkmcnt(0)
    s_barrier
    ds_read_b32 v16, v253 offset:0
    ds_read_b32 v18, v18
    s_waitcnt lgkmcnt(0)
    v_readfirstlane_b32 s42, v18
    v_add_u32 v16, 3, v16
    v_and_b32 v16, -4, v16
    v_max_u32 v16, 4, v16
    v_cndmask_b32 v16, 0, v16, vcc
    v_mov_b32 v17, v16
    s_nop 1
    v_add_u32_dpp v17, v17, v17 row_shr:1 row_mask:0xf bank_mask:0xf bound_ctrl:0
    s_nop 1
    v_add_u32_dpp v17, v17, v17 row_shr:2 row_mask:0xf bank_mask:0xf bound_ctrl:0
    s_nop 1
    v_add_u32_dpp v17, v17, v17 row_shr:4 row_mask:0xf bank_mask:0xf bound_ctrl:0
    s_nop 1
    v_add_u32_dpp v17, v17, v17 row_shr:8 row_mask:0xf bank_mask:0xf bound_ctrl:0
    s_nop 1
    v_add_u32_dpp v17, v17, v17 row_bcast:15 row_mask:0xa bank_mask:0xf
    s_nop 1
    v_add_u32_dpp v17, v17, v17 row_bcast:31 row_mask:0xc bank_mask:0xf
    s_nop 1
    v_readlane_b32 s31, v17, 63
    v_sub_u32 v250, v17, v16
    s_cmp_le_u32 s31, 3584
    s_cbranch_scc1 L_k2_fits
    s_mov_b32 s30, 2
    s_barrier
    s_branch L_k2_init
L_k2_fits:
    v_mov_b32 v17, 73216
    v_lshlrev_b32 v16, 2, v250
    v_cndmask_b32 v16, v17, v16, vcc
    ds_write_b32 v253, v16 offset:256
    v_lshrrev_b32 v16, 5, v250
    v_lshlrev_b32 v16, 2, v16
    v_bfe_u32 v17, v250, 2, 3
    v_lshlrev_b32 v17, v17, v249
    s_mov_b64 exec, vcc
    ds_or_b32 v16, v17 offset:512
    s_mov_b64 exec, -1
    v_cndmask_b32 v250, -1, v250, vcc
    s_add_u32 s31, s31, 31
    s_lshr_b32 s31, s31, 5
    s_add_u32 s33, s31, 7
    s_sub_u32 s33, s33, s28
    s_lshr_b32 s33, s33, 3
    v_lshlrev_b32 v16, 1, v253
    s_waitcnt lgkmcnt(0)
    ds_read_b64 v[20:21], v16 offset:512
    v_cmpx_lt_i32 vcc, 0, v248
    s_cbranch_execz L_k2_rd_done
    ds_read_b32 v120, v120 offset:256
    ds_read_b32 v121, v121 offset:256
    ds_read_b32 v122, v122 offset:256
    ds_read_b32 v123, v123 offset:256
    v_cmpx_lt_i32 vcc, 2, v248
    s_cbranch_execz L_k2_rd_done
    ds_read_b32 v124, v124 offset:256
    ds_read_b32 v125, v125 offset:256
    ds_read_b32 v126, v126 offset:256
    ds_read_b32 v127, v127 offset:256
    v_cmpx_lt_i32 vcc, 4, v248
    s_cbranch_execz L_k2_rd_done
    ds_read_b32 v128, v128 offset:256
    ds_read_b32 v129, v129 offset:256
    ds_read_b32 v130, v130 offset:256
    ds_read_b32 v131, v131 offset:256
    v_cmpx_lt_i32 vcc, 6, v248
    s_cbranch_execz L_k2_rd_done
    s_waitcnt lgkmcnt(8)
    ds_read_b32 v132, v132 offset:256
    ds_read_b32 v133, v133 offset:256
    ds_read_b32 v134, v134 offset:256
    ds_read_b32 v135, v135 offset:256
    v_cmpx_lt_i32 vcc, 8, v248
    s_cbranch_execz L_k2_rd_done
    s_waitcnt lgkmcnt(8)
    ds_read_b32 v136, v136 offset:256
    ds_read_b32 v137, v137 offset:256
    ds_read_b32 v138, v138 offset:256
    ds_read_b32 v139, v139 offset:256
L_k2_rd_done:
    s_mov_b64 exec, -1
    s_waitcnt lgkmcnt(0)
    v_bcnt_u32_b32 v22, v20, 0
    v_bcnt_u32_b32 v23, v21, v22
    v_mov_b32 v19, v23
    v_cmpx_lt_i32 vcc, 0, v248
    s_cbranch_execz L_k2_pl_done
    v_lshl_add_u32 v120, v140, 2, v120
    ds_write2st64_b32 v120, v164, v165 offset0:17 offset1:85
    v_lshl_add_u32 v121, v141, 2, v121
    ds_write2st64_b32 v121, v166, v167 offset0:17 offset1:85
    v_lshl_add_u32 v122, v142, 2, v122
    ds_write2st64_b32 v122, v168, v169 offset0:17 offset1:85
    v_lshl_add_u32 v123, v143, 2, v123
    ds_write2st64_b32 v123, v170, v171 offset0:17 offset1:85
    v_cmpx_lt_i32 vcc, 2, v248
    s_cbranch_execz L_k2_pl_done
    v_lshl_add_u32 v124, v144, 2, v124
    ds_write2st64_b32 v124, v172, v173 offset0:17 offset1:85
    v_lshl_add_u32 v125, v145, 2, v125
    ds_write2st64_b32 v125, v174, v175 offset0:17 offset1:85
    v_lshl_add_u32 v126, v146, 2, v126
    ds_write2st64_b32 v126, v176, v177 offset0:17 offset1:85
    v_lshl_add_u32 v127, v147, 2, v127
    ds_write2st64_b32 v127, v178, v179 offset0:17 offset1:85
    v_cmpx_lt_i32 vcc, 4, v248
    s_cbranch_execz L_k2_pl_done
    v_lshl_add_u32 v128, v148, 2, v128
    ds_write2st64_b32 v128, v180, v181 offset0:17 offset1:85
    v_lshl_add_u32 v129, v149, 2, v129
    ds_write2st64_b32 v129, v182, v183 offset0:17 offset1:85
    v_lshl_add_u32 v130, v150, 2, v130
    ds_write2st64_b32 v130, v184, v185 offset0:17 offset1:85
    v_lshl_add_u32 v131, v151, 2, v131
    ds_write2st64_b32 v131, v186, v187 offset0:17 offset1:85
    v_cmpx_lt_i32 vcc, 6, v248
    s_cbranch_execz L_k2_pl_done
    v_lshl_add_u32 v132, v152, 2, v132
    ds_write2st64_b32 v132, v188, v189 offset0:17 offset1:85
    v_lshl_add_u32 v133, v153, 2, v133
    ds_write2st64_b32 v133, v190, v191 offset0:17 offset1:85
    v_lshl_add_u32 v134, v154, 2, v134
    ds_write2st64_b32 v134, v192, v193 offset0:17 offset1:85
    v_lshl_add_u32 v135, v155, 2, v135
    ds_write2st64_b32 v135, v194, v195 offset0:17 offset1:85
    v_cmpx_lt_i32 vcc, 8, v248
    s_cbranch_execz L_k2_pl_done
    v_lshl_add_u32 v136, v156, 2, v136
    ds_write2st64_b32 v136, v196, v197 offset0:17 offset1:85
    v_lshl_add_u32 v137, v157, 2, v137
    ds_write2st64_b32 v137, v198, v199 offset0:17 offset1:85
    v_lshl_add_u32 v138, v158, 2, v138
    ds_write2st64_b32 v138, v200, v201 offset0:17 offset1:85
    v_lshl_add_u32 v139, v159, 2, v139
    ds_write2st64_b32 v139, v202, v203 offset0:17 offset1:85
L_k2_pl_done:
    s_mov_b64 exec, -1
    s_nop 3
    s_nop 1
    v_add_u32_dpp v19, v19, v19 row_shr:1 row_mask:0xf bank_mask:0xf bound_ctrl:0
    s_nop 1
    v_add_u32_dpp v19, v19, v19 row_shr:2 row_mask:0xf bank_mask:0xf bound_ctrl:0
    s_nop 1
    v_add_u32_dpp v19, v19, v19 row_shr:4 row_mask:0xf bank_mask:0xf bound_ctrl:0
    s_nop 1
    v_add_u32_dpp v19, v19, v19 row_shr:8 row_mask:0xf bank_mask:0xf bound_ctrl:0
    s_nop 1
    v_add_u32_dpp v19, v19, v19 row_bcast:15 row_mask:0xa bank_mask:0xf
    s_nop 1
    v_add_u32_dpp v19, v19, v19 row_bcast:31 row_mask:0xc bank_mask:0xf
    v_sub_u32 v19, v19, v23
    v_and_b32 v24, 1, v20
    v_add_u32 v19, 152, v19
    v_add_u32 v24, v24, v19
    v_and_b32 v25, 1, v21
    v_add3_u32 v25, v25, v19, v22
    v_lshrrev_b32 v20, 1, v20
    v_lshrrev_b32 v21, 1, v21
    v_lshl_or_b32 v24, v24, 8, v20
    v_lshl_or_b32 v25, v25, 8, v21
    ds_write_b64 v16, v[24:25] offset:2048
    s_lshl_b32 s44, s28, 2
    v_and_b32 v17, 15, v13
    v_lshl_add_u32 v17, v17, 5, s44
    v_cmp_gt_u32 vcc, s33, v13
    s_lshl_b32 s44, s28, 7
    s_add_u32 s45, s44, 4352
    s_add_u32 s44, s44, 21760
    v_lshrrev_b32 v3, 3, v13
    v_lshl_add_u32 v3, v3, 4, s45
    v_lshrrev_b32 v4, 1, v13
    v_lshl_add_u32 v4, v4, 2, s44
    s_waitcnt lgkmcnt(0)
    ds_read_b32 v5, v17 offset:2048
    s_mov_b32 s52, s54
    s_mov_b32 s34, 0
    s_mov_b32 s58, s47
    s_waitcnt lgkmcnt(0)
    s_mov_b64 s[100:101], vcc
    s_barrier
    ds_read_b32 v144, v4 offset:0
    ds_read_b32 v145, v4 offset:1024
    ds_read_b32 v146, v4 offset:2048
    ds_read_b32 v147, v4 offset:3072
    ds_read_b128 v[132:135], v3 offset:0
    ds_read_b128 v[136:139], v3 offset:1024
    ds_read_b128 v[140:143], v3 offset:2048
    v_add_u32 v3, 2048, v3
    v_add_u32 v4, 3072, v4
    s_waitcnt lgkmcnt(2)
    s_xor_b32 s52, s52, s53
    s_mov_b32 m0, s54
    v_lshl_add_u32 v12, v144, 5, v7
    buffer_load_dwordx4 v12, s[16:19], 0 offen lds
    s_mov_b32 m0, s47
    v_and_or_b32 v12, v132, s38, v6
    buffer_load_dwordx4 v12, s[12:15], 0 offen offset:0 lds
    v_and_or_b32 v12, v133, s38, v6
    buffer_load_dwordx4 v12, s[88:91], 0 offen offset:1056 lds
    v_and_or_b32 v12, v134, s38, v6
    buffer_load_dwordx4 v12, s[92:95], 0 offen offset:2112 lds
    v_and_or_b32 v12, v135, s38, v6
    buffer_load_dwordx4 v12, s[96:99], 0 offen offset:3168 lds
    s_cmp_eq_u32 s79, 0
    s_cbranch_scc1 L_k2_nojob1
    s_and_b32 s45, s28, 3
    s_lshl_b32 s45, s45, 12
    s_add_u32 s45, s45, 57600
    v_add_u32 v26, s45, v252
    v_add_u32 v15, s57, v8
    ds_read_b128 v[208:211], v26 offset:0
    ds_read_b128 v[212:215], v26 offset:1024
    ds_read_b128 v[216:219], v26 offset:2048
    ds_read_b128 v[220:223], v26 offset:3072
    ds_read_b128 v[28:31], v252 offset:39168
    ds_read_b128 v[32:35], v252 offset:40192
    ds_read_b128 v[36:39], v252 offset:41216
    ds_read_b128 v[40:43], v252 offset:42240
    ds_read_b128 v[44:47], v252 offset:43264
    ds_read_b128 v[48:51], v252 offset:44288
    ds_read_b128 v[52:55], v252 offset:45312
    ds_read_b128 v[56:59], v252 offset:46336
    ds_read_b128 v[60:63], v252 offset:47360
    ds_read_b128 v[64:67], v252 offset:48384
    ds_read_b128 v[68:71], v252 offset:49408
    ds_read_b128 v[72:75], v252 offset:50432
    ds_read_b128 v[76:79], v252 offset:51456
    ds_read_b128 v[80:83], v252 offset:52480
    ds_read_b128 v[84:87], v252 offset:53504
    ds_read_b128 v[88:91], v252 offset:54528
    ds_read_b128 v[92:95], v252 offset:55552
    ds_read_b128 v[96:99], v252 offset:56576
    v_mov_b32 v18, 0x42300000
    v_mov_b32 v19, 3072
    s_waitcnt vmcnt(5)
    ds_read_b128 v[164:167], v15 offset:0
    ds_read_b128 v[168:171], v15 offset:32
    ds_read_b128 v[172:175], v15 offset:64
    ds_read_b128 v[176:179], v15 offset:96
    s_waitcnt lgkmcnt(3)
    v_mfma_f32_32x32x16_bf16 v[148:163], v[164:167], v[208:211], 0
    s_waitcnt lgkmcnt(2)
    v_mfma_f32_32x32x16_bf16 v[148:163], v[168:171], v[212:215], v[148:163]
    s_waitcnt lgkmcnt(1)
    v_mfma_f32_32x32x16_bf16 v[148:163], v[172:175], v[216:219], v[148:163]
    s_waitcnt lgkmcnt(0)
    v_mfma_f32_32x32x16_bf16 v[148:163], v[176:179], v[220:223], v[148:163]
    s_waitcnt lgkmcnt(0)
    s_mov_b32 m0, s52
    v_lshl_add_u32 v12, v145, 5, v7
    buffer_load_dwordx4 v12, s[16:19], 0 offen lds
    s_xor_b32 s52, s52, s53
    s_lshr_b32 s44, s28, 2
    s_lshl_b32 s44, s44, 13
    s_and_b32 s45, s28, 1
    v_lshlrev_b32 v20, 6, v1
    v_add3_u32 v20, v20, v14, s44
    s_mov_b32 s46, 0xbfb8aa3b
    s_nop 4
    s_bitcmp1_b32 s28, 1
    s_cbranch_scc1 L_k2_jobu
    s_lshl_b32 s45, s45, 2
    v_add_u32 v20, s45, v20
    v_max3_f32 v17, |v148|, |v149|, |v150|
    v_max3_f32 v17, |v151|, |v152|, v17
    v_max3_f32 v17, |v153|, |v154|, v17
    v_max3_f32 v17, |v155|, |v156|, v17
    v_max3_f32 v17, |v157|, |v158|, v17
    v_max3_f32 v17, |v159|, |v160|, v17
    v_max3_f32 v17, |v161|, |v162|, v17
    v_max_f32 v17, |v163|, v17
    v_cmpx_nle_f32 vcc, v17, v18
    ds_write_b32 v19, v249
    s_mov_b64 exec, -1
    v_mul_f32 v148, s46, v148
    v_mul_f32 v149, s46, v149
    v_mul_f32 v150, s46, v150
    v_mul_f32 v151, s46, v151
    v_mul_f32 v152, s46, v152
    v_mul_f32 v153, s46, v153
    v_mul_f32 v154, s46, v154
    v_mul_f32 v155, s46, v155
    v_mul_f32 v156, s46, v156
    v_mul_f32 v157, s46, v157
    v_mul_f32 v158, s46, v158
    v_mul_f32 v159, s46, v159
    v_mul_f32 v160, s46, v160
    v_mul_f32 v161, s46, v161
    v_mul_f32 v162, s46, v162
    v_mul_f32 v163, s46, v163
    s_waitcnt lgkmcnt(0)
    s_barrier
    ds_read_b32 v19, v19
    v_exp_f32 v224, v148
    v_exp_f32 v225, v149
    v_exp_f32 v226, v150
    v_exp_f32 v227, v151
    v_exp_f32 v228, v152
    v_exp_f32 v229, v153
    v_exp_f32 v230, v154
    v_exp_f32 v231, v155
    v_exp_f32 v232, v156
    v_exp_f32 v233, v157
    v_exp_f32 v234, v158
    v_exp_f32 v235, v159
    v_exp_f32 v236, v160
    v_exp_f32 v237, v161
    v_exp_f32 v238, v162
    v_exp_f32 v239, v163
    s_waitcnt lgkmcnt(0)
    v_cmp_ne_u32 vcc, 0, v19
    s_cmp_lt_u32 s28, 4
    s_nop 0
    v_cndmask_b32 v148, v224, v148, vcc
    ds_write_b32 v20, v148 offset:39168
    v_cndmask_b32 v149, v225, v149, vcc
    ds_write_b32 v20, v149 offset:39424
    v_cndmask_b32 v150, v226, v150, vcc
    ds_write_b32 v20, v150 offset:39680
    v_cndmask_b32 v151, v227, v151, vcc
    ds_write_b32 v20, v151 offset:39936
    v_cndmask_b32 v152, v228, v152, vcc
    ds_write_b32 v20, v152 offset:41216
    v_cndmask_b32 v153, v229, v153, vcc
    ds_write_b32 v20, v153 offset:41472
    v_cndmask_b32 v154, v230, v154, vcc
    ds_write_b32 v20, v154 offset:41728
    v_cndmask_b32 v155, v231, v155, vcc
    ds_write_b32 v20, v155 offset:41984
    s_cbranch_scc1 L_k2_job2
    s_mov_b32 exec_hi, 0
L_k2_job2:
    v_cndmask_b32 v156, v232, v156, vcc
    ds_write_b32 v20, v156 offset:43264
    v_cndmask_b32 v157, v233, v157, vcc
    ds_write_b32 v20, v157 offset:43520
    s_cbranch_scc0 L_k2_job3
    v_cndmask_b32 v158, v234, v158, vcc
    ds_write_b32 v20, v158 offset:43776
    v_cndmask_b32 v159, v235, v159, vcc
    ds_write_b32 v20, v159 offset:44032
    v_cndmask_b32 v160, v236, v160, vcc
    ds_write_b32 v20, v160 offset:45312
    v_cndmask_b32 v161, v237, v161, vcc
    ds_write_b32 v20, v161 offset:45568
    v_cndmask_b32 v162, v238, v162, vcc
    ds_write_b32 v20, v162 offset:45824
    v_cndmask_b32 v163, v239, v163, vcc
    ds_write_b32 v20, v163 offset:46080
    s_branch L_k2_job3
L_k2_jobu:
    s_mul_i32 s45, s45, 12800
    v_add_u32 v20, s45, v20
    v_cvt_f64_f32 v[208:209], v148
    v_cvt_f64_f32 v[210:211], v149
    v_cvt_f64_f32 v[212:213], v150
    v_cvt_f64_f32 v[214:215], v151
    v_cvt_f64_f32 v[216:217], v152
    v_cvt_f64_f32 v[218:219], v153
    v_cvt_f64_f32 v[220:221], v154
    v_cvt_f64_f32 v[222:223], v155
    v_cvt_f64_f32 v[224:225], v156
    v_cvt_f64_f32 v[226:227], v157
    v_cvt_f64_f32 v[228:229], v158
    v_cvt_f64_f32 v[230:231], v159
    v_cvt_f64_f32 v[232:233], v160
    v_cvt_f64_f32 v[234:235], v161
    v_cvt_f64_f32 v[236:237], v162
    v_cvt_f64_f32 v[238:239], v163
    s_cmp_lt_u32 s28, 4
    s_barrier
    ds_read_b32 v19, v19
    ds_write_b64 v20, v[208:209] offset:51968
    ds_write_b64 v20, v[210:211] offset:52224
    ds_write_b64 v20, v[212:213] offset:52480
    ds_write_b64 v20, v[214:215] offset:52736
    ds_write_b64 v20, v[216:217] offset:54016
    ds_write_b64 v20, v[218:219] offset:54272
    ds_write_b64 v20, v[220:221] offset:54528
    ds_write_b64 v20, v[222:223] offset:54784
    s_cbranch_scc1 L_k2_job4
    s_mov_b32 exec_hi, 0
L_k2_job4:
    ds_write_b64 v20, v[224:225] offset:56064
    ds_write_b64 v20, v[226:227] offset:56320
    s_cbranch_scc0 L_k2_job3
    ds_write_b64 v20, v[228:229] offset:56576
    ds_write_b64 v20, v[230:231] offset:56832
    ds_write_b64 v20, v[232:233] offset:58112
    ds_write_b64 v20, v[234:235] offset:58368
    ds_write_b64 v20, v[236:237] offset:58624
    ds_write_b64 v20, v[238:239] offset:58880
L_k2_job3:
    s_mov_b64 exec, -1
    s_waitcnt lgkmcnt(0)
    v_readfirstlane_b32 s59, v19
    s_branch L_k2_nojob
L_k2_nojob1:
    s_waitcnt lgkmcnt(0)
    s_mov_b32 m0, s52
    v_lshl_add_u32 v12, v145, 5, v7
    buffer_load_dwordx4 v12, s[16:19], 0 offen lds
    s_xor_b32 s52, s52, s53
L_k2_nojob:
    s_cmp_lg_u32 s59, 0
    s_cselect_b64 s[76:77], -1, 0
    v_mov_b32 v16, 0x80
    v_cndmask_b32 v5, v16, v5, s[100:101]
    s_nop 0
    v_readfirstlane_b32 s40, v5
    s_nop 1
    v_and_or_b32 v188, s40, v242, v14
    v_add_u32 v15, s58, v8
    s_waitcnt vmcnt(1)
    v_add_u32 v10, s52, v9
    ds_read_b128 v[180:183], v10
    ds_read_b128 v[164:167], v15 offset:0
    ds_read_b128 v[168:171], v15 offset:32
    ds_read_b128 v[172:175], v15 offset:64
    ds_read_b128 v[176:179], v15 offset:96
    s_waitcnt lgkmcnt(0)
    v_mfma_f32_32x32x16_bf16 v[100:115], v[164:167], v[28:31], 0
    v_mfma_f32_32x32x16_bf16 v[100:115], v[168:171], v[32:35], v[100:115]
    v_mfma_f32_32x32x16_bf16 v[100:115], v[172:175], v[36:39], v[100:115]
    v_mfma_f32_32x32x16_bf16 v[100:115], v[176:179], v[40:43], v[100:115]
    v_mfma_f32_32x32x16_bf16 v[100:115], v[180:183], v[44:47], v[100:115]
    v_mfma_f32_32x32x16_bf16 v[116:131], v[164:167], v[68:71], 0
    v_mfma_f32_32x32x16_bf16 v[116:131], v[168:171], v[72:75], v[116:131]
    v_mfma_f32_32x32x16_bf16 v[116:131], v[172:175], v[76:79], v[116:131]
    v_mfma_f32_32x32x16_bf16 v[116:131], v[176:179], v[80:83], v[116:131]
    s_cmp_eq_u32 s79, 0
    s_cbranch_scc1 L_k2_nob4
    s_mov_b32 s79, 0
    s_barrier
L_k2_nob4:
    ds_read2_b64 v[192:195], v188 offset0:0 offset1:32
    s_mov_b32 m0, s58
    v_and_or_b32 v12, v136, s38, v6
    buffer_load_dwordx4 v12, s[12:15], 0 offen offset:0 lds
    v_and_or_b32 v12, v137, s38, v6
    buffer_load_dwordx4 v12, s[88:91], 0 offen offset:1056 lds
    v_and_or_b32 v12, v138, s38, v6
    buffer_load_dwordx4 v12, s[92:95], 0 offen offset:2112 lds
    v_and_or_b32 v12, v139, s38, v6
    buffer_load_dwordx4 v12, s[96:99], 0 offen offset:3168 lds
    s_mov_b32 m0, s52
    v_lshl_add_u32 v12, v146, 5, v7
    buffer_load_dwordx4 v12, s[16:19], 0 offen lds
    s_waitcnt lgkmcnt(0)
    s_cmp_eq_u32 s59, 0
    s_cbranch_scc1 L_dn1
    s_bitcmp1_b32 s40, 7
    s_cbranch_scc1 L_done
    s_branch L_BG
L_dn1:
    s_and_b32 s44, s40, 0xff
    s_cbranch_scc0 L_B0
    s_cmp_gt_u32 s44, 8
    s_cbranch_scc1 L_dh1
    s_cmp_eq_u32 s44, 1
    s_cbranch_scc1 L_B1
    s_cmp_eq_u32 s44, 2
    s_cbranch_scc1 L_B2
    s_cmp_eq_u32 s44, 4
    s_cbranch_scc1 L_B3
    s_cmp_eq_u32 s44, 8
    s_cbranch_scc1 L_B4
    s_branch L_BG
L_dh1:
    s_cmp_eq_u32 s44, 16
    s_cbranch_scc1 L_B5
    s_cmp_eq_u32 s44, 32
    s_cbranch_scc1 L_B6
    s_cmp_eq_u32 s44, 64
    s_cbranch_scc1 L_B7
    s_cmp_eq_u32 s44, 128
    s_cbranch_scc1 L_done
    s_branch L_BG
    .p2align 6
L_B0:
    v_mfma_f32_32x32x16_bf16 v[132:147], v[180:183], v[64:67], 0
    v_exp_f32 v100, v100
    s_add_u32 s34, s34, 1
    v_exp_f32 v101, v101
    ds_read_b128 v[184:187], v3
    v_exp_f32 v102, v102
    ds_read_b32 v11, v4
    v_exp_f32 v103, v103
    s_xor_b32 s52, s52, s53
    v_mfma_f32_32x32x16_bf16 v[132:147], v[164:167], v[48:51], v[132:147]
    v_exp_f32 v104, v104
    v_readlane_b32 s40, v5, s34
    v_exp_f32 v105, v105
    v_exp_f32 v106, v106
    v_exp_f32 v107, v107
    v_mfma_f32_32x32x16_bf16 v[148:163], v[164:167], v[84:87], 0
    v_exp_f32 v108, v108
    v_exp_f32 v109, v109
    v_exp_f32 v110, v110
    v_mfma_f32_32x32x16_bf16 v[132:147], v[168:171], v[52:55], v[132:147]
    v_exp_f32 v111, v111
    v_exp_f32 v112, v112
    v_exp_f32 v113, v113
    v_exp_f32 v114, v114
    v_exp_f32 v115, v115
    s_waitcnt lgkmcnt(2)
    v_pk_fma_f32 v[100:101], v[100:101], v[192:193], s[36:37] op_sel_hi:[1,0,1]
    v_pk_fma_f32 v[102:103], v[102:103], v[192:193], s[36:37] op_sel_hi:[1,0,1]
    v_pk_fma_f32 v[104:105], v[104:105], v[192:193], s[36:37] op_sel_hi:[1,0,1]
    v_pk_fma_f32 v[106:107], v[106:107], v[192:193], s[36:37] op_sel_hi:[1,0,1]
    v_pk_fma_f32 v[108:109], v[108:109], v[192:193], s[36:37] op_sel_hi:[1,0,1]
    v_pk_fma_f32 v[110:111], v[110:111], v[192:193], s[36:37] op_sel_hi:[1,0,1]
    v_pk_fma_f32 v[112:113], v[112:113], v[192:193], s[36:37] op_sel_hi:[1,0,1]
    v_pk_fma_f32 v[114:115], v[114:115], v[192:193], s[36:37] op_sel_hi:[1,0,1]
    v_mfma_f32_32x32x16_bf16 v[148:163], v[168:171], v[88:91], v[148:163]
    v_rcp_f32 v100, v100
    v_rcp_f32 v101, v101
    v_add_u32 v10, s52, v9
    v_rcp_f32 v102, v102
    v_mfma_f32_32x32x16_bf16 v[132:147], v[172:175], v[56:59], v[132:147]
    v_rcp_f32 v103, v103
    v_rcp_f32 v104, v104
    v_rcp_f32 v105, v105
    v_mfma_f32_32x32x16_bf16 v[148:163], v[172:175], v[92:95], v[148:163]
    v_rcp_f32 v106, v106
    v_rcp_f32 v107, v107
    v_rcp_f32 v108, v108
    v_mfma_f32_32x32x16_bf16 v[132:147], v[176:179], v[60:63], v[132:147]
    v_rcp_f32 v109, v109
    v_rcp_f32 v110, v110
    v_mov_b32 v220, v193
    v_mfma_f32_32x32x16_bf16 v[148:163], v[176:179], v[96:99], v[148:163]
    v_rcp_f32 v111, v111
    v_rcp_f32 v112, v112
    v_rcp_f32 v113, v113
    v_rcp_f32 v114, v114
    v_rcp_f32 v115, v115
    s_nop 0
    v_pk_mul_f32 v[100:101], v[100:101], v[116:117]
    s_waitcnt vmcnt(1)
    ds_read_b128 v[180:183], v10
    ds_read_b128 v[164:167], v15 offset:0
    ds_read_b128 v[168:171], v15 offset:32
    ds_read_b128 v[172:175], v15 offset:64
    ds_read_b128 v[176:179], v15 offset:96
    v_pk_fma_f32 v[100:101], v[102:103], v[118:119], v[100:101]
    v_pk_fma_f32 v[100:101], v[104:105], v[120:121], v[100:101]
    v_pk_fma_f32 v[100:101], v[106:107], v[122:123], v[100:101]
    v_pk_fma_f32 v[100:101], v[108:109], v[124:125], v[100:101]
    v_pk_fma_f32 v[100:101], v[110:111], v[126:127], v[100:101]
    v_pk_fma_f32 v[100:101], v[112:113], v[128:129], v[100:101]
    v_pk_fma_f32 v[100:101], v[114:115], v[130:131], v[100:101]
    v_add_f32 v100, v100, v101
    v_cvt_f64_f32 v[20:21], v100
    ds_add_f64 v188, v[20:21] offset:12800
    s_waitcnt lgkmcnt(3)
    v_mfma_f32_32x32x16_bf16 v[100:115], v[180:183], v[44:47], 0
    v_exp_f32 v132, v132
    v_exp_f32 v133, v133
    v_exp_f32 v134, v134
    v_exp_f32 v135, v135
    v_mfma_f32_32x32x16_bf16 v[100:115], v[164:167], v[28:31], v[100:115]
    v_exp_f32 v136, v136
    v_exp_f32 v137, v137
    v_exp_f32 v138, v138
    v_exp_f32 v139, v139
    v_mfma_f32_32x32x16_bf16 v[116:131], v[164:167], v[68:71], 0
    v_exp_f32 v140, v140
    v_exp_f32 v141, v141
    v_exp_f32 v142, v142
    s_waitcnt lgkmcnt(1)
    v_mfma_f32_32x32x16_bf16 v[100:115], v[168:171], v[32:35], v[100:115]
    s_mov_b32 m0, s58
    v_exp_f32 v143, v143
    v_and_or_b32 v12, v184, s38, v6
    buffer_load_dwordx4 v12, s[12:15], 0 offen offset:0 lds
    v_exp_f32 v144, v144
    v_and_or_b32 v12, v185, s38, v6
    buffer_load_dwordx4 v12, s[88:91], 0 offen offset:1056 lds
    v_exp_f32 v145, v145
    v_and_or_b32 v12, v186, s38, v6
    buffer_load_dwordx4 v12, s[92:95], 0 offen offset:2112 lds
    v_exp_f32 v146, v146
    v_and_or_b32 v12, v187, s38, v6
    buffer_load_dwordx4 v12, s[96:99], 0 offen offset:3168 lds
    v_exp_f32 v147, v147
    s_mov_b32 m0, s52
    v_lshl_add_u32 v12, v11, 5, v7
    buffer_load_dwordx4 v12, s[16:19], 0 offen lds
    v_pk_fma_f32 v[132:133], v[132:133], v[220:221], s[36:37] op_sel_hi:[1,0,1]
    v_pk_fma_f32 v[134:135], v[134:135], v[220:221], s[36:37] op_sel_hi:[1,0,1]
    v_pk_fma_f32 v[136:137], v[136:137], v[220:221], s[36:37] op_sel_hi:[1,0,1]
    v_pk_fma_f32 v[138:139], v[138:139], v[220:221], s[36:37] op_sel_hi:[1,0,1]
    v_pk_fma_f32 v[140:141], v[140:141], v[220:221], s[36:37] op_sel_hi:[1,0,1]
    v_pk_fma_f32 v[142:143], v[142:143], v[220:221], s[36:37] op_sel_hi:[1,0,1]
    v_pk_fma_f32 v[144:145], v[144:145], v[220:221], s[36:37] op_sel_hi:[1,0,1]
    v_pk_fma_f32 v[146:147], v[146:147], v[220:221], s[36:37] op_sel_hi:[1,0,1]
    v_mfma_f32_32x32x16_bf16 v[116:131], v[168:171], v[72:75], v[116:131]
    v_rcp_f32 v132, v132
    v_rcp_f32 v133, v133
    v_rcp_f32 v134, v134
    v_mfma_f32_32x32x16_bf16 v[100:115], v[172:175], v[36:39], v[100:115]
    v_rcp_f32 v135, v135
    v_rcp_f32 v136, v136
    v_rcp_f32 v137, v137
    v_mfma_f32_32x32x16_bf16 v[116:131], v[172:175], v[76:79], v[116:131]
    v_rcp_f32 v138, v138
    v_rcp_f32 v139, v139
    v_rcp_f32 v140, v140
    v_add_u32 v3, 1024, v3
    v_mfma_f32_32x32x16_bf16 v[100:115], v[176:179], v[40:43], v[100:115]
    v_rcp_f32 v141, v141
    v_rcp_f32 v142, v142
    v_add_u32 v4, 1024, v4
    v_mfma_f32_32x32x16_bf16 v[116:131], v[176:179], v[80:83], v[116:131]
    v_rcp_f32 v143, v143
    v_rcp_f32 v144, v144
    v_rcp_f32 v145, v145
    v_rcp_f32 v146, v146
    v_rcp_f32 v147, v147
    s_nop 0
    v_pk_mul_f32 v[132:133], v[132:133], v[148:149]
    v_pk_fma_f32 v[132:133], v[134:135], v[150:151], v[132:133]
    v_pk_fma_f32 v[132:133], v[136:137], v[152:153], v[132:133]
    v_pk_fma_f32 v[132:133], v[138:139], v[154:155], v[132:133]
    v_pk_fma_f32 v[132:133], v[140:141], v[156:157], v[132:133]
    v_pk_fma_f32 v[132:133], v[142:143], v[158:159], v[132:133]
    v_pk_fma_f32 v[132:133], v[144:145], v[160:161], v[132:133]
    v_pk_fma_f32 v[132:133], v[146:147], v[162:163], v[132:133]
    v_add_f32 v132, v132, v133
    v_cvt_f64_f32 v[20:21], v132
    ds_add_f64 v188, v[20:21] offset:25600
    v_and_or_b32 v188, s40, v242, v14
    ds_read2_b64 v[192:195], v188 offset0:0 offset1:32
    s_and_b32 s44, s40, 0xff
    s_cbranch_scc0 L_B0
    s_cmp_gt_u32 s44, 8
    s_cbranch_scc1 L_dh2
    s_cmp_eq_u32 s44, 1
    s_cbranch_scc1 L_B1
    s_cmp_eq_u32 s44, 2
    s_cbranch_scc1 L_B2
    s_cmp_eq_u32 s44, 4
    s_cbranch_scc1 L_B3
    s_cmp_eq_u32 s44, 8
    s_cbranch_scc1 L_B4
    s_branch L_BG
L_dh2:
    s_cmp_eq_u32 s44, 16
    s_cbranch_scc1 L_B5
    s_cmp_eq_u32 s44, 32
    s_cbranch_scc1 L_B6
    s_cmp_eq_u32 s44, 64
    s_cbranch_scc1 L_B7
    s_cmp_eq_u32 s44, 128
    s_cbranch_scc1 L_done
    s_branch L_BG
    .p2align 6
L_B1:
    v_mfma_f32_32x32x16_bf16 v[132:147], v[180:183], v[64:67], 0
    v_exp_f32 v100, v100
    s_add_u32 s34, s34, 1
    v_exp_f32 v101, v101
    ds_read_b128 v[184:187], v3
    v_exp_f32 v102, v102
    ds_read_b32 v11, v4
    v_exp_f32 v103, v103
    s_xor_b32 s52, s52, s53
    v_mfma_f32_32x32x16_bf16 v[132:147], v[164:167], v[48:51], v[132:147]
    v_exp_f32 v104, v104
    v_readlane_b32 s40, v5, s34
    v_exp_f32 v105, v105
    v_exp_f32 v106, v106
    v_exp_f32 v107, v107
    v_mfma_f32_32x32x16_bf16 v[148:163], v[164:167], v[84:87], 0
    v_exp_f32 v108, v108
    v_exp_f32 v109, v109
    v_exp_f32 v110, v110
    v_mfma_f32_32x32x16_bf16 v[132:147], v[168:171], v[52:55], v[132:147]
    v_exp_f32 v111, v111
    v_exp_f32 v112, v112
    v_exp_f32 v113, v113
    v_exp_f32 v114, v114
    v_exp_f32 v115, v115
    s_waitcnt lgkmcnt(2)
    v_pk_fma_f32 v[100:101], v[100:101], v[192:193], s[36:37] op_sel_hi:[1,0,1]
    v_pk_fma_f32 v[102:103], v[102:103], v[194:195], s[36:37] op_sel_hi:[1,0,1]
    v_pk_fma_f32 v[104:105], v[104:105], v[194:195], s[36:37] op_sel_hi:[1,0,1]
    v_pk_fma_f32 v[106:107], v[106:107], v[194:195], s[36:37] op_sel_hi:[1,0,1]
    v_pk_fma_f32 v[108:109], v[108:109], v[194:195], s[36:37] op_sel_hi:[1,0,1]
    v_pk_fma_f32 v[110:111], v[110:111], v[194:195], s[36:37] op_sel_hi:[1,0,1]
    v_pk_fma_f32 v[112:113], v[112:113], v[194:195], s[36:37] op_sel_hi:[1,0,1]
    v_pk_fma_f32 v[114:115], v[114:115], v[194:195], s[36:37] op_sel_hi:[1,0,1]
    v_mfma_f32_32x32x16_bf16 v[148:163], v[168:171], v[88:91], v[148:163]
    v_rcp_f32 v100, v100
    v_rcp_f32 v101, v101
    v_add_u32 v10, s52, v9
    v_rcp_f32 v102, v102
    v_mfma_f32_32x32x16_bf16 v[132:147], v[172:175], v[56:59], v[132:147]
    v_rcp_f32 v103, v103
    v_rcp_f32 v104, v104
    v_rcp_f32 v105, v105
    v_mfma_f32_32x32x16_bf16 v[148:163], v[172:175], v[92:95], v[148:163]
    v_rcp_f32 v106, v106
    v_rcp_f32 v107, v107
    v_rcp_f32 v108, v108
    v_mfma_f32_32x32x16_bf16 v[132:147], v[176:179], v[60:63], v[132:147]
    v_rcp_f32 v109, v109
    v_rcp_f32 v110, v110
    v_mov_b32 v220, v193
    v_mov_b32 v222, v195
    v_mfma_f32_32x32x16_bf16 v[148:163], v[176:179], v[96:99], v[148:163]
    v_rcp_f32 v111, v111
    v_rcp_f32 v112, v112
    v_rcp_f32 v113, v113
    v_rcp_f32 v114, v114
    v_rcp_f32 v115, v115
    s_nop 0
    v_pk_mul_f32 v[100:101], v[100:101], v[116:117]
    s_waitcnt vmcnt(1)
    ds_read_b128 v[180:183], v10
    ds_read_b128 v[164:167], v15 offset:0
    ds_read_b128 v[168:171], v15 offset:32
    ds_read_b128 v[172:175], v15 offset:64
    ds_read_b128 v[176:179], v15 offset:96
    v_pk_mul_f32 v[102:103], v[102:103], v[118:119]
    v_pk_fma_f32 v[102:103], v[104:105], v[120:121], v[102:103]
    v_pk_fma_f32 v[102:103], v[106:107], v[122:123], v[102:103]
    v_pk_fma_f32 v[102:103], v[108:109], v[124:125], v[102:103]
    v_pk_fma_f32 v[102:103], v[110:111], v[126:127], v[102:103]
    v_pk_fma_f32 v[102:103], v[112:113], v[128:129], v[102:103]
    v_pk_fma_f32 v[102:103], v[114:115], v[130:131], v[102:103]
    v_add_f32 v100, v100, v101
    v_add_f32 v102, v102, v103
    v_cvt_f64_f32 v[20:21], v100
    v_cvt_f64_f32 v[22:23], v102
    ds_add_f64 v188, v[20:21] offset:12800
    ds_add_f64 v188, v[22:23] offset:13056
    s_waitcnt lgkmcnt(4)
    v_mfma_f32_32x32x16_bf16 v[100:115], v[180:183], v[44:47], 0
    v_exp_f32 v132, v132
    v_exp_f32 v133, v133
    v_exp_f32 v134, v134
    v_exp_f32 v135, v135
    v_mfma_f32_32x32x16_bf16 v[100:115], v[164:167], v[28:31], v[100:115]
    v_exp_f32 v136, v136
    v_exp_f32 v137, v137
    v_exp_f32 v138, v138
    v_exp_f32 v139, v139
    v_mfma_f32_32x32x16_bf16 v[116:131], v[164:167], v[68:71], 0
    v_exp_f32 v140, v140
    v_exp_f32 v141, v141
    v_exp_f32 v142, v142
    s_waitcnt lgkmcnt(2)
    v_mfma_f32_32x32x16_bf16 v[100:115], v[168:171], v[32:35], v[100:115]
    s_mov_b32 m0, s58
    v_exp_f32 v143, v143
    v_and_or_b32 v12, v184, s38, v6
    buffer_load_dwordx4 v12, s[12:15], 0 offen offset:0 lds
    v_exp_f32 v144, v144
    v_and_or_b32 v12, v185, s38, v6
    buffer_load_dwordx4 v12, s[88:91], 0 offen offset:1056 lds
    v_exp_f32 v145, v145
    v_and_or_b32 v12, v186, s38, v6
    buffer_load_dwordx4 v12, s[92:95], 0 offen offset:2112 lds
    v_exp_f32 v146, v146
    v_and_or_b32 v12, v187, s38, v6
    buffer_load_dwordx4 v12, s[96:99], 0 offen offset:3168 lds
    v_exp_f32 v147, v147
    s_mov_b32 m0, s52
    v_lshl_add_u32 v12, v11, 5, v7
    buffer_load_dwordx4 v12, s[16:19], 0 offen lds
    v_pk_fma_f32 v[132:133], v[132:133], v[220:221], s[36:37] op_sel_hi:[1,0,1]
    v_pk_fma_f32 v[134:135], v[134:135], v[222:223], s[36:37] op_sel_hi:[1,0,1]
    v_pk_fma_f32 v[136:137], v[136:137], v[222:223], s[36:37] op_sel_hi:[1,0,1]
    v_pk_fma_f32 v[138:139], v[138:139], v[222:223], s[36:37] op_sel_hi:[1,0,1]
    v_pk_fma_f32 v[140:141], v[140:141], v[222:223], s[36:37] op_sel_hi:[1,0,1]
    v_pk_fma_f32 v[142:143], v[142:143], v[222:223], s[36:37] op_sel_hi:[1,0,1]
    v_pk_fma_f32 v[144:145], v[144:145], v[222:223], s[36:37] op_sel_hi:[1,0,1]
    v_pk_fma_f32 v[146:147], v[146:147], v[222:223], s[36:37] op_sel_hi:[1,0,1]
    v_mfma_f32_32x32x16_bf16 v[116:131], v[168:171], v[72:75], v[116:131]
    v_rcp_f32 v132, v132
    v_rcp_f32 v133, v133
    v_rcp_f32 v134, v134
    v_mfma_f32_32x32x16_bf16 v[100:115], v[172:175], v[36:39], v[100:115]
    v_rcp_f32 v135, v135
    v_rcp_f32 v136, v136
    v_rcp_f32 v137, v137
    v_mfma_f32_32x32x16_bf16 v[116:131], v[172:175], v[76:79], v[116:131]
    v_rcp_f32 v138, v138
    v_rcp_f32 v139, v139
    v_rcp_f32 v140, v140
    v_add_u32 v3, 1024, v3
    v_mfma_f32_32x32x16_bf16 v[100:115], v[176:179], v[40:43], v[100:115]
    v_rcp_f32 v141, v141
    v_rcp_f32 v142, v142
    v_add_u32 v4, 1024, v4
    v_mfma_f32_32x32x16_bf16 v[116:131], v[176:179], v[80:83], v[116:131]
    v_rcp_f32 v143, v143
    v_rcp_f32 v144, v144
    v_rcp_f32 v145, v145
    v_rcp_f32 v146, v146
    v_rcp_f32 v147, v147
    s_nop 0
    v_pk_mul_f32 v[132:133], v[132:133], v[148:149]
    v_pk_mul_f32 v[134:135], v[134:135], v[150:151]
    v_pk_fma_f32 v[134:135], v[136:137], v[152:153], v[134:135]
    v_pk_fma_f32 v[134:135], v[138:139], v[154:155], v[134:135]
    v_pk_fma_f32 v[134:135], v[140:141], v[156:157], v[134:135]
    v_pk_fma_f32 v[134:135], v[142:143], v[158:159], v[134:135]
    v_pk_fma_f32 v[134:135], v[144:145], v[160:161], v[134:135]
    v_pk_fma_f32 v[134:135], v[146:147], v[162:163], v[134:135]
    v_add_f32 v132, v132, v133
    v_add_f32 v134, v134, v135
    v_cvt_f64_f32 v[20:21], v132
    v_cvt_f64_f32 v[22:23], v134
    ds_add_f64 v188, v[20:21] offset:25600
    ds_add_f64 v188, v[22:23] offset:25856
    v_and_or_b32 v188, s40, v242, v14
    ds_read2_b64 v[192:195], v188 offset0:0 offset1:32
    s_and_b32 s44, s40, 0xff
    s_cbranch_scc0 L_B0
    s_cmp_gt_u32 s44, 8
    s_cbranch_scc1 L_dh3
    s_cmp_eq_u32 s44, 1
    s_cbranch_scc1 L_B1
    s_cmp_eq_u32 s44, 2
    s_cbranch_scc1 L_B2
    s_cmp_eq_u32 s44, 4
    s_cbranch_scc1 L_B3
    s_cmp_eq_u32 s44, 8
    s_cbranch_scc1 L_B4
    s_branch L_BG
L_dh3:
    s_cmp_eq_u32 s44, 16
    s_cbranch_scc1 L_B5
    s_cmp_eq_u32 s44, 32
    s_cbranch_scc1 L_B6
    s_cmp_eq_u32 s44, 64
    s_cbranch_scc1 L_B7
    s_cmp_eq_u32 s44, 128
    s_cbranch_scc1 L_done
    s_branch L_BG
    .p2align 6
L_B2:
    v_mfma_f32_32x32x16_bf16 v[132:147], v[180:183], v[64:67], 0
    v_exp_f32 v100, v100
    s_add_u32 s34, s34, 1
    v_exp_f32 v101, v101
    ds_read_b128 v[184:187], v3
    v_exp_f32 v102, v102
    ds_read_b32 v11, v4
    v_exp_f32 v103, v103
    s_xor_b32 s52, s52, s53
    v_mfma_f32_32x32x16_bf16 v[132:147], v[164:167], v[48:51], v[132:147]
    v_exp_f32 v104, v104
    v_readlane_b32 s40, v5, s34
    v_exp_f32 v105, v105
    v_exp_f32 v106, v106
    v_exp_f32 v107, v107
    v_mfma_f32_32x32x16_bf16 v[148:163], v[164:167], v[84:87], 0
    v_exp_f32 v108, v108
    v_exp_f32 v109, v109
    v_exp_f32 v110, v110
    v_mfma_f32_32x32x16_bf16 v[132:147], v[168:171], v[52:55], v[132:147]
    v_exp_f32 v111, v111
    v_exp_f32 v112, v112
    v_exp_f32 v113, v113
    v_exp_f32 v114, v114
    v_exp_f32 v115, v115
    s_waitcnt lgkmcnt(2)
    v_pk_fma_f32 v[100:101], v[100:101], v[192:193], s[36:37] op_sel_hi:[1,0,1]
    v_pk_fma_f32 v[102:103], v[102:103], v[192:193], s[36:37] op_sel_hi:[1,0,1]
    v_pk_fma_f32 v[104:105], v[104:105], v[194:195], s[36:37] op_sel_hi:[1,0,1]
    v_pk_fma_f32 v[106:107], v[106:107], v[194:195], s[36:37] op_sel_hi:[1,0,1]
    v_pk_fma_f32 v[108:109], v[108:109], v[194:195], s[36:37] op_sel_hi:[1,0,1]
    v_pk_fma_f32 v[110:111], v[110:111], v[194:195], s[36:37] op_sel_hi:[1,0,1]
    v_pk_fma_f32 v[112:113], v[112:113], v[194:195], s[36:37] op_sel_hi:[1,0,1]
    v_pk_fma_f32 v[114:115], v[114:115], v[194:195], s[36:37] op_sel_hi:[1,0,1]
    v_mfma_f32_32x32x16_bf16 v[148:163], v[168:171], v[88:91], v[148:163]
    v_rcp_f32 v100, v100
    v_rcp_f32 v101, v101
    v_add_u32 v10, s52, v9
    v_rcp_f32 v102, v102
    v_mfma_f32_32x32x16_bf16 v[132:147], v[172:175], v[56:59], v[132:147]
    v_rcp_f32 v103, v103
    v_rcp_f32 v104, v104
    v_rcp_f32 v105, v105
    v_mfma_f32_32x32x16_bf16 v[148:163], v[172:175], v[92:95], v[148:163]
    v_rcp_f32 v106, v106
    v_rcp_f32 v107, v107
    v_rcp_f32 v108, v108
    v_mfma_f32_32x32x16_bf16 v[132:147], v[176:179], v[60:63], v[132:147]
    v_rcp_f32 v109, v109
    v_rcp_f32 v110, v110
    v_mov_b32 v220, v193
    v_mov_b32 v222, v195
    v_mfma_f32_32x32x16_bf16 v[148:163], v[176:179], v[96:99], v[148:163]
    v_rcp_f32 v111, v111
    v_rcp_f32 v112, v112
    v_rcp_f32 v113, v113
    v_rcp_f32 v114, v114
    v_rcp_f32 v115, v115
    s_nop 0
    v_pk_mul_f32 v[100:101], v[100:101], v[116:117]
    s_waitcnt vmcnt(1)
    ds_read_b128 v[180:183], v10
    ds_read_b128 v[164:167], v15 offset:0
    ds_read_b128 v[168:171], v15 offset:32
    ds_read_b128 v[172:175], v15 offset:64
    ds_read_b128 v[176:179], v15 offset:96
    v_pk_fma_f32 v[100:101], v[102:103], v[118:119], v[100:101]
    v_pk_mul_f32 v[104:105], v[104:105], v[120:121]
    v_pk_fma_f32 v[104:105], v[106:107], v[122:123], v[104:105]
    v_pk_fma_f32 v[104:105], v[108:109], v[124:125], v[104:105]
    v_pk_fma_f32 v[104:105], v[110:111], v[126:127], v[104:105]
    v_pk_fma_f32 v[104:105], v[112:113], v[128:129], v[104:105]
    v_pk_fma_f32 v[104:105], v[114:115], v[130:131], v[104:105]
    v_add_f32 v100, v100, v101
    v_add_f32 v104, v104, v105
    v_cvt_f64_f32 v[20:21], v100
    v_cvt_f64_f32 v[22:23], v104
    ds_add_f64 v188, v[20:21] offset:12800
    ds_add_f64 v188, v[22:23] offset:13056
    s_waitcnt lgkmcnt(4)
    v_mfma_f32_32x32x16_bf16 v[100:115], v[180:183], v[44:47], 0
    v_exp_f32 v132, v132
    v_exp_f32 v133, v133
    v_exp_f32 v134, v134
    v_exp_f32 v135, v135
    v_mfma_f32_32x32x16_bf16 v[100:115], v[164:167], v[28:31], v[100:115]
    v_exp_f32 v136, v136
    v_exp_f32 v137, v137
    v_exp_f32 v138, v138
    v_exp_f32 v139, v139
    v_mfma_f32_32x32x16_bf16 v[116:131], v[164:167], v[68:71], 0
    v_exp_f32 v140, v140
    v_exp_f32 v141, v141
    v_exp_f32 v142, v142
    s_waitcnt lgkmcnt(2)
    v_mfma_f32_32x32x16_bf16 v[100:115], v[168:171], v[32:35], v[100:115]
    s_mov_b32 m0, s58
    v_exp_f32 v143, v143
    v_and_or_b32 v12, v184, s38, v6
    buffer_load_dwordx4 v12, s[12:15], 0 offen offset:0 lds
    v_exp_f32 v144, v144
    v_and_or_b32 v12, v185, s38, v6
    buffer_load_dwordx4 v12, s[88:91], 0 offen offset:1056 lds
    v_exp_f32 v145, v145
    v_and_or_b32 v12, v186, s38, v6
    buffer_load_dwordx4 v12, s[92:95], 0 offen offset:2112 lds
    v_exp_f32 v146, v146
    v_and_or_b32 v12, v187, s38, v6
    buffer_load_dwordx4 v12, s[96:99], 0 offen offset:3168 lds
    v_exp_f32 v147, v147
    s_mov_b32 m0, s52
    v_lshl_add_u32 v12, v11, 5, v7
    buffer_load_dwordx4 v12, s[16:19], 0 offen lds
    v_pk_fma_f32 v[132:133], v[132:133], v[220:221], s[36:37] op_sel_hi:[1,0,1]
    v_pk_fma_f32 v[134:135], v[134:135], v[220:221], s[36:37] op_sel_hi:[1,0,1]
    v_pk_fma_f32 v[136:137], v[136:137], v[222:223], s[36:37] op_sel_hi:[1,0,1]
    v_pk_fma_f32 v[138:139], v[138:139], v[222:223], s[36:37] op_sel_hi:[1,0,1]
    v_pk_fma_f32 v[140:141], v[140:141], v[222:223], s[36:37] op_sel_hi:[1,0,1]
    v_pk_fma_f32 v[142:143], v[142:143], v[222:223], s[36:37] op_sel_hi:[1,0,1]
    v_pk_fma_f32 v[144:145], v[144:145], v[222:223], s[36:37] op_sel_hi:[1,0,1]
    v_pk_fma_f32 v[146:147], v[146:147], v[222:223], s[36:37] op_sel_hi:[1,0,1]
    v_mfma_f32_32x32x16_bf16 v[116:131], v[168:171], v[72:75], v[116:131]
    v_rcp_f32 v132, v132
    v_rcp_f32 v133, v133
    v_rcp_f32 v134, v134
    v_mfma_f32_32x32x16_bf16 v[100:115], v[172:175], v[36:39], v[100:115]
    v_rcp_f32 v135, v135
    v_rcp_f32 v136, v136
    v_rcp_f32 v137, v137
    v_mfma_f32_32x32x16_bf16 v[116:131], v[172:175], v[76:79], v[116:131]
    v_rcp_f32 v138, v138
    v_rcp_f32 v139, v139
    v_rcp_f32 v140, v140
    v_add_u32 v3, 1024, v3
    v_mfma_f32_32x32x16_bf16 v[100:115], v[176:179], v[40:43], v[100:115]
    v_rcp_f32 v141, v141
    v_rcp_f32 v142, v142
    v_add_u32 v4, 1024, v4
    v_mfma_f32_32x32x16_bf16 v[116:131], v[176:179], v[80:83], v[116:131]
    v_rcp_f32 v143, v143
    v_rcp_f32 v144, v144
    v_rcp_f32 v145, v145
    v_rcp_f32 v146, v146
    v_rcp_f32 v147, v147
    s_nop 0
    v_pk_mul_f32 v[132:133], v[132:133], v[148:149]
    v_pk_fma_f32 v[132:133], v[134:135], v[150:151], v[132:133]
    v_pk_mul_f32 v[136:137], v[136:137], v[152:153]
    v_pk_fma_f32 v[136:137], v[138:139], v[154:155], v[136:137]
    v_pk_fma_f32 v[136:137], v[140:141], v[156:157], v[136:137]
    v_pk_fma_f32 v[136:137], v[142:143], v[158:159], v[136:137]
    v_pk_fma_f32 v[136:137], v[144:145], v[160:161], v[136:137]
    v_pk_fma_f32 v[136:137], v[146:147], v[162:163], v[136:137]
    v_add_f32 v132, v132, v133
    v_add_f32 v136, v136, v137
    v_cvt_f64_f32 v[20:21], v132
    v_cvt_f64_f32 v[22:23], v136
    ds_add_f64 v188, v[20:21] offset:25600
    ds_add_f64 v188, v[22:23] offset:25856
    v_and_or_b32 v188, s40, v242, v14
    ds_read2_b64 v[192:195], v188 offset0:0 offset1:32
    s_and_b32 s44, s40, 0xff
    s_cbranch_scc0 L_B0
    s_cmp_gt_u32 s44, 8
    s_cbranch_scc1 L_dh4
    s_cmp_eq_u32 s44, 1
    s_cbranch_scc1 L_B1
    s_cmp_eq_u32 s44, 2
    s_cbranch_scc1 L_B2
    s_cmp_eq_u32 s44, 4
    s_cbranch_scc1 L_B3
    s_cmp_eq_u32 s44, 8
    s_cbranch_scc1 L_B4
    s_branch L_BG
L_dh4:
    s_cmp_eq_u32 s44, 16
    s_cbranch_scc1 L_B5
    s_cmp_eq_u32 s44, 32
    s_cbranch_scc1 L_B6
    s_cmp_eq_u32 s44, 64
    s_cbranch_scc1 L_B7
    s_cmp_eq_u32 s44, 128
    s_cbranch_scc1 L_done
    s_branch L_BG
    .p2align 6
L_B3:
    v_mfma_f32_32x32x16_bf16 v[132:147], v[180:183], v[64:67], 0
    v_exp_f32 v100, v100
    s_add_u32 s34, s34, 1
    v_exp_f32 v101, v101
    ds_read_b128 v[184:187], v3
    v_exp_f32 v102, v102
    ds_read_b32 v11, v4
    v_exp_f32 v103, v103
    s_xor_b32 s52, s52, s53
    v_mfma_f32_32x32x16_bf16 v[132:147], v[164:167], v[48:51], v[132:147]
    v_exp_f32 v104, v104
    v_readlane_b32 s40, v5, s34
    v_exp_f32 v105, v105
    v_exp_f32 v106, v106
    v_exp_f32 v107, v107
    v_mfma_f32_32x32x16_bf16 v[148:163], v[164:167], v[84:87], 0
    v_exp_f32 v108, v108
    v_exp_f32 v109, v109
    v_exp_f32 v110, v110
    v_mfma_f32_32x32x16_bf16 v[132:147], v[168:171], v[52:55], v[132:147]
    v_exp_f32 v111, v111
    v_exp_f32 v112, v112
    v_exp_f32 v113, v113
    v_exp_f32 v114, v114
    v_exp_f32 v115, v115
    s_waitcnt lgkmcnt(2)
    v_pk_fma_f32 v[100:101], v[100:101], v[192:193], s[36:37] op_sel_hi:[1,0,1]
    v_pk_fma_f32 v[102:103], v[102:103], v[192:193], s[36:37] op_sel_hi:[1,0,1]
    v_pk_fma_f32 v[104:105], v[104:105], v[192:193], s[36:37] op_sel_hi:[1,0,1]
    v_pk_fma_f32 v[106:107], v[106:107], v[194:195], s[36:37] op_sel_hi:[1,0,1]
    v_pk_fma_f32 v[108:109], v[108:109], v[194:195], s[36:37] op_sel_hi:[1,0,1]
    v_pk_fma_f32 v[110:111], v[110:111], v[194:195], s[36:37] op_sel_hi:[1,0,1]
    v_pk_fma_f32 v[112:113], v[112:113], v[194:195], s[36:37] op_sel_hi:[1,0,1]
    v_pk_fma_f32 v[114:115], v[114:115], v[194:195], s[36:37] op_sel_hi:[1,0,1]
    v_mfma_f32_32x32x16_bf16 v[148:163], v[168:171], v[88:91], v[148:163]
    v_rcp_f32 v100, v100
    v_rcp_f32 v101, v101
    v_add_u32 v10, s52, v9
    v_rcp_f32 v102, v102
    v_mfma_f32_32x32x16_bf16 v[132:147], v[172:175], v[56:59], v[132:147]
    v_rcp_f32 v103, v103
    v_rcp_f32 v104, v104
    v_rcp_f32 v105, v105
    v_mfma_f32_32x32x16_bf16 v[148:163], v[172:175], v[92:95], v[148:163]
    v_rcp_f32 v106, v106
    v_rcp_f32 v107, v107
    v_rcp_f32 v108, v108
    v_mfma_f32_32x32x16_bf16 v[132:147], v[176:179], v[60:63], v[132:147]
    v_rcp_f32 v109, v109
    v_rcp_f32 v110, v110
    v_mov_b32 v220, v193
    v_mov_b32 v222, v195
    v_mfma_f32_32x32x16_bf16 v[148:163], v[176:179], v[96:99], v[148:163]
    v_rcp_f32 v111, v111
    v_rcp_f32 v112, v112
    v_rcp_f32 v113, v113
    v_rcp_f32 v114, v114
    v_rcp_f32 v115, v115
    s_nop 0
    v_pk_mul_f32 v[100:101], v[100:101], v[116:117]
    s_waitcnt vmcnt(1)
    ds_read_b128 v[180:183], v10
    ds_read_b128 v[164:167], v15 offset:0
    ds_read_b128 v[168:171], v15 offset:32
    ds_read_b128 v[172:175], v15 offset:64
    ds_read_b128 v[176:179], v15 offset:96
    v_pk_fma_f32 v[100:101], v[102:103], v[118:119], v[100:101]
    v_pk_fma_f32 v[100:101], v[104:105], v[120:121], v[100:101]
    v_pk_mul_f32 v[106:107], v[106:107], v[122:123]
    v_pk_fma_f32 v[106:107], v[108:109], v[124:125], v[106:107]
    v_pk_fma_f32 v[106:107], v[110:111], v[126:127], v[106:107]
    v_pk_fma_f32 v[106:107], v[112:113], v[128:129], v[106:107]
    v_pk_fma_f32 v[106:107], v[114:115], v[130:131], v[106:107]
    v_add_f32 v100, v100, v101
    v_add_f32 v106, v106, v107
    v_cvt_f64_f32 v[20:21], v100
    v_cvt_f64_f32 v[22:23], v106
    ds_add_f64 v188, v[20:21] offset:12800
    ds_add_f64 v188, v[22:23] offset:13056
    s_waitcnt lgkmcnt(4)
    v_mfma_f32_32x32x16_bf16 v[100:115], v[180:183], v[44:47], 0
    v_exp_f32 v132, v132
    v_exp_f32 v133, v133
    v_exp_f32 v134, v134
    v_exp_f32 v135, v135
    v_mfma_f32_32x32x16_bf16 v[100:115], v[164:167], v[28:31], v[100:115]
    v_exp_f32 v136, v136
    v_exp_f32 v137, v137
    v_exp_f32 v138, v138
    v_exp_f32 v139, v139
    v_mfma_f32_32x32x16_bf16 v[116:131], v[164:167], v[68:71], 0
    v_exp_f32 v140, v140
    v_exp_f32 v141, v141
    v_exp_f32 v142, v142
    s_waitcnt lgkmcnt(2)
    v_mfma_f32_32x32x16_bf16 v[100:115], v[168:171], v[32:35], v[100:115]
    s_mov_b32 m0, s58
    v_exp_f32 v143, v143
    v_and_or_b32 v12, v184, s38, v6
    buffer_load_dwordx4 v12, s[12:15], 0 offen offset:0 lds
    v_exp_f32 v144, v144
    v_and_or_b32 v12, v185, s38, v6
    buffer_load_dwordx4 v12, s[88:91], 0 offen offset:1056 lds
    v_exp_f32 v145, v145
    v_and_or_b32 v12, v186, s38, v6
    buffer_load_dwordx4 v12, s[92:95], 0 offen offset:2112 lds
    v_exp_f32 v146, v146
    v_and_or_b32 v12, v187, s38, v6
    buffer_load_dwordx4 v12, s[96:99], 0 offen offset:3168 lds
    v_exp_f32 v147, v147
    s_mov_b32 m0, s52
    v_lshl_add_u32 v12, v11, 5, v7
    buffer_load_dwordx4 v12, s[16:19], 0 offen lds
    v_pk_fma_f32 v[132:133], v[132:133], v[220:221], s[36:37] op_sel_hi:[1,0,1]
    v_pk_fma_f32 v[134:135], v[134:135], v[220:221], s[36:37] op_sel_hi:[1,0,1]
    v_pk_fma_f32 v[136:137], v[136:137], v[220:221], s[36:37] op_sel_hi:[1,0,1]
    v_pk_fma_f32 v[138:139], v[138:139], v[222:223], s[36:37] op_sel_hi:[1,0,1]
    v_pk_fma_f32 v[140:141], v[140:141], v[222:223], s[36:37] op_sel_hi:[1,0,1]
    v_pk_fma_f32 v[142:143], v[142:143], v[222:223], s[36:37] op_sel_hi:[1,0,1]
    v_pk_fma_f32 v[144:145], v[144:145], v[222:223], s[36:37] op_sel_hi:[1,0,1]
    v_pk_fma_f32 v[146:147], v[146:147], v[222:223], s[36:37] op_sel_hi:[1,0,1]
    v_mfma_f32_32x32x16_bf16 v[116:131], v[168:171], v[72:75], v[116:131]
    v_rcp_f32 v132, v132
    v_rcp_f32 v133, v133
    v_rcp_f32 v134, v134
    v_mfma_f32_32x32x16_bf16 v[100:115], v[172:175], v[36:39], v[100:115]
    v_rcp_f32 v135, v135
    v_rcp_f32 v136, v136
    v_rcp_f32 v137, v137
    v_mfma_f32_32x32x16_bf16 v[116:131], v[172:175], v[76:79], v[116:131]
    v_rcp_f32 v138, v138
    v_rcp_f32 v139, v139
    v_rcp_f32 v140, v140
    v_add_u32 v3, 1024, v3
    v_mfma_f32_32x32x16_bf16 v[100:115], v[176:179], v[40:43], v[100:115]
    v_rcp_f32 v141, v141
    v_rcp_f32 v142, v142
    v_add_u32 v4, 1024, v4
    v_mfma_f32_32x32x16_bf16 v[116:131], v[176:179], v[80:83], v[116:131]
    v_rcp_f32 v143, v143
    v_rcp_f32 v144, v144
    v_rcp_f32 v145, v145
    v_rcp_f32 v146, v146
    v_rcp_f32 v147, v147
    s_nop 0
    v_pk_mul_f32 v[132:133], v[132:133], v[148:149]
    v_pk_fma_f32 v[132:133], v[134:135], v[150:151], v[132:133]
    v_pk_fma_f32 v[132:133], v[136:137], v[152:153], v[132:133]
    v_pk_mul_f32 v[138:139], v[138:139], v[154:155]
    v_pk_fma_f32 v[138:139], v[140:141], v[156:157], v[138:139]
    v_pk_fma_f32 v[138:139], v[142:143], v[158:159], v[138:139]
    v_pk_fma_f32 v[138:139], v[144:145], v[160:161], v[138:139]
    v_pk_fma_f32 v[138:139], v[146:147], v[162:163], v[138:139]
    v_add_f32 v132, v132, v133
    v_add_f32 v138, v138, v139
    v_cvt_f64_f32 v[20:21], v132
    v_cvt_f64_f32 v[22:23], v138
    ds_add_f64 v188, v[20:21] offset:25600
    ds_add_f64 v188, v[22:23] offset:25856
    v_and_or_b32 v188, s40, v242, v14
    ds_read2_b64 v[192:195], v188 offset0:0 offset1:32
    s_and_b32 s44, s40, 0xff
    s_cbranch_scc0 L_B0
    s_cmp_gt_u32 s44, 8
    s_cbranch_scc1 L_dh5
    s_cmp_eq_u32 s44, 1
    s_cbranch_scc1 L_B1
    s_cmp_eq_u32 s44, 2
    s_cbranch_scc1 L_B2
    s_cmp_eq_u32 s44, 4
    s_cbranch_scc1 L_B3
    s_cmp_eq_u32 s44, 8
    s_cbranch_scc1 L_B4
    s_branch L_BG
L_dh5:
    s_cmp_eq_u32 s44, 16
    s_cbranch_scc1 L_B5
    s_cmp_eq_u32 s44, 32
    s_cbranch_scc1 L_B6
    s_cmp_eq_u32 s44, 64
    s_cbranch_scc1 L_B7
    s_cmp_eq_u32 s44, 128
    s_cbranch_scc1 L_done
    s_branch L_BG
    .p2align 6
L_B4:
    v_mfma_f32_32x32x16_bf16 v[132:147], v[180:183], v[64:67], 0
    v_exp_f32 v100, v100
    s_add_u32 s34, s34, 1
    v_exp_f32 v101, v101
    ds_read_b128 v[184:187], v3
    v_exp_f32 v102, v102
    ds_read_b32 v11, v4
    v_exp_f32 v103, v103
    s_xor_b32 s52, s52, s53
    v_mfma_f32_32x32x16_bf16 v[132:147], v[164:167], v[48:51], v[132:147]
    v_exp_f32 v104, v104
    v_readlane_b32 s40, v5, s34
    v_exp_f32 v105, v105
    v_exp_f32 v106, v106
    v_exp_f32 v107, v107
    v_mfma_f32_32x32x16_bf16 v[148:163], v[164:167], v[84:87], 0
    v_exp_f32 v108, v108
    v_exp_f32 v109, v109
    v_exp_f32 v110, v110
    v_mfma_f32_32x32x16_bf16 v[132:147], v[168:171], v[52:55], v[132:147]
    v_exp_f32 v111, v111
    v_exp_f32 v112, v112
    v_exp_f32 v113, v113
    v_exp_f32 v114, v114
    v_exp_f32 v115, v115
    s_waitcnt lgkmcnt(2)
    v_pk_fma_f32 v[100:101], v[100:101], v[192:193], s[36:37] op_sel_hi:[1,0,1]
    v_pk_fma_f32 v[102:103], v[102:103], v[192:193], s[36:37] op_sel_hi:[1,0,1]
    v_pk_fma_f32 v[104:105], v[104:105], v[192:193], s[36:37] op_sel_hi:[1,0,1]
    v_pk_fma_f32 v[106:107], v[106:107], v[192:193], s[36:37] op_sel_hi:[1,0,1]
    v_pk_fma_f32 v[108:109], v[108:109], v[194:195], s[36:37] op_sel_hi:[1,0,1]
    v_pk_fma_f32 v[110:111], v[110:111], v[194:195], s[36:37] op_sel_hi:[1,0,1]
    v_pk_fma_f32 v[112:113], v[112:113], v[194:195], s[36:37] op_sel_hi:[1,0,1]
    v_pk_fma_f32 v[114:115], v[114:115], v[194:195], s[36:37] op_sel_hi:[1,0,1]
    v_mfma_f32_32x32x16_bf16 v[148:163], v[168:171], v[88:91], v[148:163]
    v_rcp_f32 v100, v100
    v_rcp_f32 v101, v101
    v_add_u32 v10, s52, v9
    v_rcp_f32 v102, v102
    v_mfma_f32_32x32x16_bf16 v[132:147], v[172:175], v[56:59], v[132:147]
    v_rcp_f32 v103, v103
    v_rcp_f32 v104, v104
    v_rcp_f32 v105, v105
    v_mfma_f32_32x32x16_bf16 v[148:163], v[172:175], v[92:95], v[148:163]
    v_rcp_f32 v106, v106
    v_rcp_f32 v107, v107
    v_rcp_f32 v108, v108
    v_mfma_f32_32x32x16_bf16 v[132:147], v[176:179], v[60:63], v[132:147]
    v_rcp_f32 v109, v109
    v_rcp_f32 v110, v110
    v_mov_b32 v220, v193
    v_mov_b32 v222, v195
    v_mfma_f32_32x32x16_bf16 v[148:163], v[176:179], v[96:99], v[148:163]
    v_rcp_f32 v111, v111
    v_rcp_f32 v112, v112
    v_rcp_f32 v113, v113
    v_rcp_f32 v114, v114
    v_rcp_f32 v115, v115
    s_nop 0
    v_pk_mul_f32 v[100:101], v[100:101], v[116:117]
    s_waitcnt vmcnt(1)
    ds_read_b128 v[180:183], v10
    ds_read_b128 v[164:167], v15 offset:0
    ds_read_b128 v[168:171], v15 offset:32
    ds_read_b128 v[172:175], v15 offset:64
    ds_read_b128 v[176:179], v15 offset:96
    v_pk_fma_f32 v[100:101], v[102:103], v[118:119], v[100:101]
    v_pk_fma_f32 v[100:101], v[104:105], v[120:121], v[100:101]
    v_pk_fma_f32 v[100:101], v[106:107], v[122:123], v[100:101]
    v_pk_mul_f32 v[108:109], v[108:109], v[124:125]
    v_pk_fma_f32 v[108:109], v[110:111], v[126:127], v[108:109]
    v_pk_fma_f32 v[108:109], v[112:113], v[128:129], v[108:109]
    v_pk_fma_f32 v[108:109], v[114:115], v[130:131], v[108:109]
    v_add_f32 v100, v100, v101
    v_add_f32 v108, v108, v109
    v_cvt_f64_f32 v[20:21], v100
    v_cvt_f64_f32 v[22:23], v108
    ds_add_f64 v188, v[20:21] offset:12800
    ds_add_f64 v188, v[22:23] offset:13056
    s_waitcnt lgkmcnt(4)
    v_mfma_f32_32x32x16_bf16 v[100:115], v[180:183], v[44:47], 0
    v_exp_f32 v132, v132
    v_exp_f32 v133, v133
    v_exp_f32 v134, v134
    v_exp_f32 v135, v135
    v_mfma_f32_32x32x16_bf16 v[100:115], v[164:167], v[28:31], v[100:115]
    v_exp_f32 v136, v136
    v_exp_f32 v137, v137
    v_exp_f32 v138, v138
    v_exp_f32 v139, v139
    v_mfma_f32_32x32x16_bf16 v[116:131], v[164:167], v[68:71], 0
    v_exp_f32 v140, v140
    v_exp_f32 v141, v141
    v_exp_f32 v142, v142
    s_waitcnt lgkmcnt(2)
    v_mfma_f32_32x32x16_bf16 v[100:115], v[168:171], v[32:35], v[100:115]
    s_mov_b32 m0, s58
    v_exp_f32 v143, v143
    v_and_or_b32 v12, v184, s38, v6
    buffer_load_dwordx4 v12, s[12:15], 0 offen offset:0 lds
    v_exp_f32 v144, v144
    v_and_or_b32 v12, v185, s38, v6
    buffer_load_dwordx4 v12, s[88:91], 0 offen offset:1056 lds
    v_exp_f32 v145, v145
    v_and_or_b32 v12, v186, s38, v6
    buffer_load_dwordx4 v12, s[92:95], 0 offen offset:2112 lds
    v_exp_f32 v146, v146
    v_and_or_b32 v12, v187, s38, v6
    buffer_load_dwordx4 v12, s[96:99], 0 offen offset:3168 lds
    v_exp_f32 v147, v147
    s_mov_b32 m0, s52
    v_lshl_add_u32 v12, v11, 5, v7
    buffer_load_dwordx4 v12, s[16:19], 0 offen lds
    v_pk_fma_f32 v[132:133], v[132:133], v[220:221], s[36:37] op_sel_hi:[1,0,1]
    v_pk_fma_f32 v[134:135], v[134:135], v[220:221], s[36:37] op_sel_hi:[1,0,1]
    v_pk_fma_f32 v[136:137], v[136:137], v[220:221], s[36:37] op_sel_hi:[1,0,1]
    v_pk_fma_f32 v[138:139], v[138:139], v[220:221], s[36:37] op_sel_hi:[1,0,1]
    v_pk_fma_f32 v[140:141], v[140:141], v[222:223], s[36:37] op_sel_hi:[1,0,1]
    v_pk_fma_f32 v[142:143], v[142:143], v[222:223], s[36:37] op_sel_hi:[1,0,1]
    v_pk_fma_f32 v[144:145], v[144:145], v[222:223], s[36:37] op_sel_hi:[1,0,1]
    v_pk_fma_f32 v[146:147], v[146:147], v[222:223], s[36:37] op_sel_hi:[1,0,1]
    v_mfma_f32_32x32x16_bf16 v[116:131], v[168:171], v[72:75], v[116:131]
    v_rcp_f32 v132, v132
    v_rcp_f32 v133, v133
    v_rcp_f32 v134, v134
    v_mfma_f32_32x32x16_bf16 v[100:115], v[172:175], v[36:39], v[100:115]
    v_rcp_f32 v135, v135
    v_rcp_f32 v136, v136
    v_rcp_f32 v137, v137
    v_mfma_f32_32x32x16_bf16 v[116:131], v[172:175], v[76:79], v[116:131]
    v_rcp_f32 v138, v138
    v_rcp_f32 v139, v139
    v_rcp_f32 v140, v140
    v_add_u32 v3, 1024, v3
    v_mfma_f32_32x32x16_bf16 v[100:115], v[176:179], v[40:43], v[100:115]
    v_rcp_f32 v141, v141
    v_rcp_f32 v142, v142
    v_add_u32 v4, 1024, v4
    v_mfma_f32_32x32x16_bf16 v[116:131], v[176:179], v[80:83], v[116:131]
    v_rcp_f32 v143, v143
    v_rcp_f32 v144, v144
    v_rcp_f32 v145, v145
    v_rcp_f32 v146, v146
    v_rcp_f32 v147, v147
    s_nop 0
    v_pk_mul_f32 v[132:133], v[132:133], v[148:149]
    v_pk_fma_f32 v[132:133], v[134:135], v[150:151], v[132:133]
    v_pk_fma_f32 v[132:133], v[136:137], v[152:153], v[132:133]
    v_pk_fma_f32 v[132:133], v[138:139], v[154:155], v[132:133]
    v_pk_mul_f32 v[140:141], v[140:141], v[156:157]
    v_pk_fma_f32 v[140:141], v[142:143], v[158:159], v[140:141]
    v_pk_fma_f32 v[140:141], v[144:145], v[160:161], v[140:141]
    v_pk_fma_f32 v[140:141], v[146:147], v[162:163], v[140:141]
    v_add_f32 v132, v132, v133
    v_add_f32 v140, v140, v141
    v_cvt_f64_f32 v[20:21], v132
    v_cvt_f64_f32 v[22:23], v140
    ds_add_f64 v188, v[20:21] offset:25600
    ds_add_f64 v188, v[22:23] offset:25856
    v_and_or_b32 v188, s40, v242, v14
    ds_read2_b64 v[192:195], v188 offset0:0 offset1:32
    s_and_b32 s44, s40, 0xff
    s_cbranch_scc0 L_B0
    s_cmp_gt_u32 s44, 8
    s_cbranch_scc1 L_dh6
    s_cmp_eq_u32 s44, 1
    s_cbranch_scc1 L_B1
    s_cmp_eq_u32 s44, 2
    s_cbranch_scc1 L_B2
    s_cmp_eq_u32 s44, 4
    s_cbranch_scc1 L_B3
    s_cmp_eq_u32 s44, 8
    s_cbranch_scc1 L_B4
    s_branch L_BG
L_dh6:
    s_cmp_eq_u32 s44, 16
    s_cbranch_scc1 L_B5
    s_cmp_eq_u32 s44, 32
    s_cbranch_scc1 L_B6
    s_cmp_eq_u32 s44, 64
    s_cbranch_scc1 L_B7
    s_cmp_eq_u32 s44, 128
    s_cbranch_scc1 L_done
    s_branch L_BG
    .p2align 6
L_B5:
    v_mfma_f32_32x32x16_bf16 v[132:147], v[180:183], v[64:67], 0
    v_exp_f32 v100, v100
    s_add_u32 s34, s34, 1
    v_exp_f32 v101, v101
    ds_read_b128 v[184:187], v3
    v_exp_f32 v102, v102
    ds_read_b32 v11, v4
    v_exp_f32 v103, v103
    s_xor_b32 s52, s52, s53
    v_mfma_f32_32x32x16_bf16 v[132:147], v[164:167], v[48:51], v[132:147]
    v_exp_f32 v104, v104
    v_readlane_b32 s40, v5, s34
    v_exp_f32 v105, v105
    v_exp_f32 v106, v106
    v_exp_f32 v107, v107
    v_mfma_f32_32x32x16_bf16 v[148:163], v[164:167], v[84:87], 0
    v_exp_f32 v108, v108
    v_exp_f32 v109, v109
    v_exp_f32 v110, v110
    v_mfma_f32_32x32x16_bf16 v[132:147], v[168:171], v[52:55], v[132:147]
    v_exp_f32 v111, v111
    v_exp_f32 v112, v112
    v_exp_f32 v113, v113
    v_exp_f32 v114, v114
    v_exp_f32 v115, v115
    s_waitcnt lgkmcnt(2)
    v_pk_fma_f32 v[100:101], v[100:101], v[192:193], s[36:37] op_sel_hi:[1,0,1]
    v_pk_fma_f32 v[102:103], v[102:103], v[192:193], s[36:37] op_sel_hi:[1,0,1]
    v_pk_fma_f32 v[104:105], v[104:105], v[192:193], s[36:37] op_sel_hi:[1,0,1]
    v_pk_fma_f32 v[106:107], v[106:107], v[192:193], s[36:37] op_sel_hi:[1,0,1]
    v_pk_fma_f32 v[108:109], v[108:109], v[192:193], s[36:37] op_sel_hi:[1,0,1]
    v_pk_fma_f32 v[110:111], v[110:111], v[194:195], s[36:37] op_sel_hi:[1,0,1]
    v_pk_fma_f32 v[112:113], v[112:113], v[194:195], s[36:37] op_sel_hi:[1,0,1]
    v_pk_fma_f32 v[114:115], v[114:115], v[194:195], s[36:37] op_sel_hi:[1,0,1]
    v_mfma_f32_32x32x16_bf16 v[148:163], v[168:171], v[88:91], v[148:163]
    v_rcp_f32 v100, v100
    v_rcp_f32 v101, v101
    v_add_u32 v10, s52, v9
    v_rcp_f32 v102, v102
    v_mfma_f32_32x32x16_bf16 v[132:147], v[172:175], v[56:59], v[132:147]
    v_rcp_f32 v103, v103
    v_rcp_f32 v104, v104
    v_rcp_f32 v105, v105
    v_mfma_f32_32x32x16_bf16 v[148:163], v[172:175], v[92:95], v[148:163]
    v_rcp_f32 v106, v106
    v_rcp_f32 v107, v107
    v_rcp_f32 v108, v108
    v_mfma_f32_32x32x16_bf16 v[132:147], v[176:179], v[60:63], v[132:147]
    v_rcp_f32 v109, v109
    v_rcp_f32 v110, v110
    v_mov_b32 v220, v193
    v_mov_b32 v222, v195
    v_mfma_f32_32x32x16_bf16 v[148:163], v[176:179], v[96:99], v[148:163]
    v_rcp_f32 v111, v111
    v_rcp_f32 v112, v112
    v_rcp_f32 v113, v113
    v_rcp_f32 v114, v114
    v_rcp_f32 v115, v115
    s_nop 0
    v_pk_mul_f32 v[100:101], v[100:101], v[116:117]
    s_waitcnt vmcnt(1)
    ds_read_b128 v[180:183], v10
    ds_read_b128 v[164:167], v15 offset:0
    ds_read_b128 v[168:171], v15 offset:32
    ds_read_b128 v[172:175], v15 offset:64
    ds_read_b128 v[176:179], v15 offset:96
    v_pk_fma_f32 v[100:101], v[102:103], v[118:119], v[100:101]
    v_pk_fma_f32 v[100:101], v[104:105], v[120:121], v[100:101]
    v_pk_fma_f32 v[100:101], v[106:107], v[122:123], v[100:101]
    v_pk_fma_f32 v[100:101], v[108:109], v[124:125], v[100:101]
    v_pk_mul_f32 v[110:111], v[110:111], v[126:127]
    v_pk_fma_f32 v[110:111], v[112:113], v[128:129], v[110:111]
    v_pk_fma_f32 v[110:111], v[114:115], v[130:131], v[110:111]
    v_add_f32 v100, v100, v101
    v_add_f32 v110, v110, v111
    v_cvt_f64_f32 v[20:21], v100
    v_cvt_f64_f32 v[22:23], v110
    ds_add_f64 v188, v[20:21] offset:12800
    ds_add_f64 v188, v[22:23] offset:13056
    s_waitcnt lgkmcnt(4)
    v_mfma_f32_32x32x16_bf16 v[100:115], v[180:183], v[44:47], 0
    v_exp_f32 v132, v132
    v_exp_f32 v133, v133
    v_exp_f32 v134, v134
    v_exp_f32 v135, v135
    v_mfma_f32_32x32x16_bf16 v[100:115], v[164:167], v[28:31], v[100:115]
    v_exp_f32 v136, v136
    v_exp_f32 v137, v137
    v_exp_f32 v138, v138
    v_exp_f32 v139, v139
    v_mfma_f32_32x32x16_bf16 v[116:131], v[164:167], v[68:71], 0
    v_exp_f32 v140, v140
    v_exp_f32 v141, v141
    v_exp_f32 v142, v142
    s_waitcnt lgkmcnt(2)
    v_mfma_f32_32x32x16_bf16 v[100:115], v[168:171], v[32:35], v[100:115]
    s_mov_b32 m0, s58
    v_exp_f32 v143, v143
    v_and_or_b32 v12, v184, s38, v6
    buffer_load_dwordx4 v12, s[12:15], 0 offen offset:0 lds
    v_exp_f32 v144, v144
    v_and_or_b32 v12, v185, s38, v6
    buffer_load_dwordx4 v12, s[88:91], 0 offen offset:1056 lds
    v_exp_f32 v145, v145
    v_and_or_b32 v12, v186, s38, v6
    buffer_load_dwordx4 v12, s[92:95], 0 offen offset:2112 lds
    v_exp_f32 v146, v146
    v_and_or_b32 v12, v187, s38, v6
    buffer_load_dwordx4 v12, s[96:99], 0 offen offset:3168 lds
    v_exp_f32 v147, v147
    s_mov_b32 m0, s52
    v_lshl_add_u32 v12, v11, 5, v7
    buffer_load_dwordx4 v12, s[16:19], 0 offen lds
    v_pk_fma_f32 v[132:133], v[132:133], v[220:221], s[36:37] op_sel_hi:[1,0,1]
    v_pk_fma_f32 v[134:135], v[134:135], v[220:221], s[36:37] op_sel_hi:[1,0,1]
    v_pk_fma_f32 v[136:137], v[136:137], v[220:221], s[36:37] op_sel_hi:[1,0,1]
    v_pk_fma_f32 v[138:139], v[138:139], v[220:221], s[36:37] op_sel_hi:[1,0,1]
    v_pk_fma_f32 v[140:141], v[140:141], v[220:221], s[36:37] op_sel_hi:[1,0,1]
    v_pk_fma_f32 v[142:143], v[142:143], v[222:223], s[36:37] op_sel_hi:[1,0,1]
    v_pk_fma_f32 v[144:145], v[144:145], v[222:223], s[36:37] op_sel_hi:[1,0,1]
    v_pk_fma_f32 v[146:147], v[146:147], v[222:223], s[36:37] op_sel_hi:[1,0,1]
    v_mfma_f32_32x32x16_bf16 v[116:131], v[168:171], v[72:75], v[116:131]
    v_rcp_f32 v132, v132
    v_rcp_f32 v133, v133
    v_rcp_f32 v134, v134
    v_mfma_f32_32x32x16_bf16 v[100:115], v[172:175], v[36:39], v[100:115]
    v_rcp_f32 v135, v135
    v_rcp_f32 v136, v136
    v_rcp_f32 v137, v137
    v_mfma_f32_32x32x16_bf16 v[116:131], v[172:175], v[76:79], v[116:131]
    v_rcp_f32 v138, v138
    v_rcp_f32 v139, v139
    v_rcp_f32 v140, v140
    v_add_u32 v3, 1024, v3
    v_mfma_f32_32x32x16_bf16 v[100:115], v[176:179], v[40:43], v[100:115]
    v_rcp_f32 v141, v141
    v_rcp_f32 v142, v142
    v_add_u32 v4, 1024, v4
    v_mfma_f32_32x32x16_bf16 v[116:131], v[176:179], v[80:83], v[116:131]
    v_rcp_f32 v143, v143
    v_rcp_f32 v144, v144
    v_rcp_f32 v145, v145
    v_rcp_f32 v146, v146
    v_rcp_f32 v147, v147
    s_nop 0
    v_pk_mul_f32 v[132:133], v[132:133], v[148:149]
    v_pk_fma_f32 v[132:133], v[134:135], v[150:151], v[132:133]
    v_pk_fma_f32 v[132:133], v[136:137], v[152:153], v[132:133]
    v_pk_fma_f32 v[132:133], v[138:139], v[154:155], v[132:133]
    v_pk_fma_f32 v[132:133], v[140:141], v[156:157], v[132:133]
    v_pk_mul_f32 v[142:143], v[142:143], v[158:159]
    v_pk_fma_f32 v[142:143], v[144:145], v[160:161], v[142:143]
    v_pk_fma_f32 v[142:143], v[146:147], v[162:163], v[142:143]
    v_add_f32 v132, v132, v133
    v_add_f32 v142, v142, v143
    v_cvt_f64_f32 v[20:21], v132
    v_cvt_f64_f32 v[22:23], v142
    ds_add_f64 v188, v[20:21] offset:25600
    ds_add_f64 v188, v[22:23] offset:25856
    v_and_or_b32 v188, s40, v242, v14
    ds_read2_b64 v[192:195], v188 offset0:0 offset1:32
    s_and_b32 s44, s40, 0xff
    s_cbranch_scc0 L_B0
    s_cmp_gt_u32 s44, 8
    s_cbranch_scc1 L_dh7
    s_cmp_eq_u32 s44, 1
    s_cbranch_scc1 L_B1
    s_cmp_eq_u32 s44, 2
    s_cbranch_scc1 L_B2
    s_cmp_eq_u32 s44, 4
    s_cbranch_scc1 L_B3
    s_cmp_eq_u32 s44, 8
    s_cbranch_scc1 L_B4
    s_branch L_BG
L_dh7:
    s_cmp_eq_u32 s44, 16
    s_cbranch_scc1 L_B5
    s_cmp_eq_u32 s44, 32
    s_cbranch_scc1 L_B6
    s_cmp_eq_u32 s44, 64
    s_cbranch_scc1 L_B7
    s_cmp_eq_u32 s44, 128
    s_cbranch_scc1 L_done
    s_branch L_BG
    .p2align 6
L_B6:
    v_mfma_f32_32x32x16_bf16 v[132:147], v[180:183], v[64:67], 0
    v_exp_f32 v100, v100
    s_add_u32 s34, s34, 1
    v_exp_f32 v101, v101
    ds_read_b128 v[184:187], v3
    v_exp_f32 v102, v102
    ds_read_b32 v11, v4
    v_exp_f32 v103, v103
    s_xor_b32 s52, s52, s53
    v_mfma_f32_32x32x16_bf16 v[132:147], v[164:167], v[48:51], v[132:147]
    v_exp_f32 v104, v104
    v_readlane_b32 s40, v5, s34
    v_exp_f32 v105, v105
    v_exp_f32 v106, v106
    v_exp_f32 v107, v107
    v_mfma_f32_32x32x16_bf16 v[148:163], v[164:167], v[84:87], 0
    v_exp_f32 v108, v108
    v_exp_f32 v109, v109
    v_exp_f32 v110, v110
    v_mfma_f32_32x32x16_bf16 v[132:147], v[168:171], v[52:55], v[132:147]
    v_exp_f32 v111, v111
    v_exp_f32 v112, v112
    v_exp_f32 v113, v113
    v_exp_f32 v114, v114
    v_exp_f32 v115, v115
    s_waitcnt lgkmcnt(2)
    v_pk_fma_f32 v[100:101], v[100:101], v[192:193], s[36:37] op_sel_hi:[1,0,1]
    v_pk_fma_f32 v[102:103], v[102:103], v[192:193], s[36:37] op_sel_hi:[1,0,1]
    v_pk_fma_f32 v[104:105], v[104:105], v[192:193], s[36:37] op_sel_hi:[1,0,1]
    v_pk_fma_f32 v[106:107], v[106:107], v[192:193], s[36:37] op_sel_hi:[1,0,1]
    v_pk_fma_f32 v[108:109], v[108:109], v[192:193], s[36:37] op_sel_hi:[1,0,1]
    v_pk_fma_f32 v[110:111], v[110:111], v[192:193], s[36:37] op_sel_hi:[1,0,1]
    v_pk_fma_f32 v[112:113], v[112:113], v[194:195], s[36:37] op_sel_hi:[1,0,1]
    v_pk_fma_f32 v[114:115], v[114:115], v[194:195], s[36:37] op_sel_hi:[1,0,1]
    v_mfma_f32_32x32x16_bf16 v[148:163], v[168:171], v[88:91], v[148:163]
    v_rcp_f32 v100, v100
    v_rcp_f32 v101, v101
    v_add_u32 v10, s52, v9
    v_rcp_f32 v102, v102
    v_mfma_f32_32x32x16_bf16 v[132:147], v[172:175], v[56:59], v[132:147]
    v_rcp_f32 v103, v103
    v_rcp_f32 v104, v104
    v_rcp_f32 v105, v105
    v_mfma_f32_32x32x16_bf16 v[148:163], v[172:175], v[92:95], v[148:163]
    v_rcp_f32 v106, v106
    v_rcp_f32 v107, v107
    v_rcp_f32 v108, v108
    v_mfma_f32_32x32x16_bf16 v[132:147], v[176:179], v[60:63], v[132:147]
    v_rcp_f32 v109, v109
    v_rcp_f32 v110, v110
    v_mov_b32 v220, v193
    v_mov_b32 v222, v195
    v_mfma_f32_32x32x16_bf16 v[148:163], v[176:179], v[96:99], v[148:163]
    v_rcp_f32 v111, v111
    v_rcp_f32 v112, v112
    v_rcp_f32 v113, v113
    v_rcp_f32 v114, v114
    v_rcp_f32 v115, v115
    s_nop 0
    v_pk_mul_f32 v[100:101], v[100:101], v[116:117]
    s_waitcnt vmcnt(1)
    ds_read_b128 v[180:183], v10
    ds_read_b128 v[164:167], v15 offset:0
    ds_read_b128 v[168:171], v15 offset:32
    ds_read_b128 v[172:175], v15 offset:64
    ds_read_b128 v[176:179], v15 offset:96
    v_pk_fma_f32 v[100:101], v[102:103], v[118:119], v[100:101]
    v_pk_fma_f32 v[100:101], v[104:105], v[120:121], v[100:101]
    v_pk_fma_f32 v[100:101], v[106:107], v[122:123], v[100:101]
    v_pk_fma_f32 v[100:101], v[108:109], v[124:125], v[100:101]
    v_pk_fma_f32 v[100:101], v[110:111], v[126:127], v[100:101]
    v_pk_mul_f32 v[112:113], v[112:113], v[128:129]
    v_pk_fma_f32 v[112:113], v[114:115], v[130:131], v[112:113]
    v_add_f32 v100, v100, v101
    v_add_f32 v112, v112, v113
    v_cvt_f64_f32 v[20:21], v100
    v_cvt_f64_f32 v[22:23], v112
    ds_add_f64 v188, v[20:21] offset:12800
    ds_add_f64 v188, v[22:23] offset:13056
    s_waitcnt lgkmcnt(4)
    v_mfma_f32_32x32x16_bf16 v[100:115], v[180:183], v[44:47], 0
    v_exp_f32 v132, v132
    v_exp_f32 v133, v133
    v_exp_f32 v134, v134
    v_exp_f32 v135, v135
    v_mfma_f32_32x32x16_bf16 v[100:115], v[164:167], v[28:31], v[100:115]
    v_exp_f32 v136, v136
    v_exp_f32 v137, v137
    v_exp_f32 v138, v138
    v_exp_f32 v139, v139
    v_mfma_f32_32x32x16_bf16 v[116:131], v[164:167], v[68:71], 0
    v_exp_f32 v140, v140
    v_exp_f32 v141, v141
    v_exp_f32 v142, v142
    s_waitcnt lgkmcnt(2)
    v_mfma_f32_32x32x16_bf16 v[100:115], v[168:171], v[32:35], v[100:115]
    s_mov_b32 m0, s58
    v_exp_f32 v143, v143
    v_and_or_b32 v12, v184, s38, v6
    buffer_load_dwordx4 v12, s[12:15], 0 offen offset:0 lds
    v_exp_f32 v144, v144
    v_and_or_b32 v12, v185, s38, v6
    buffer_load_dwordx4 v12, s[88:91], 0 offen offset:1056 lds
    v_exp_f32 v145, v145
    v_and_or_b32 v12, v186, s38, v6
    buffer_load_dwordx4 v12, s[92:95], 0 offen offset:2112 lds
    v_exp_f32 v146, v146
    v_and_or_b32 v12, v187, s38, v6
    buffer_load_dwordx4 v12, s[96:99], 0 offen offset:3168 lds
    v_exp_f32 v147, v147
    s_mov_b32 m0, s52
    v_lshl_add_u32 v12, v11, 5, v7
    buffer_load_dwordx4 v12, s[16:19], 0 offen lds
    v_pk_fma_f32 v[132:133], v[132:133], v[220:221], s[36:37] op_sel_hi:[1,0,1]
    v_pk_fma_f32 v[134:135], v[134:135], v[220:221], s[36:37] op_sel_hi:[1,0,1]
    v_pk_fma_f32 v[136:137], v[136:137], v[220:221], s[36:37] op_sel_hi:[1,0,1]
    v_pk_fma_f32 v[138:139], v[138:139], v[220:221], s[36:37] op_sel_hi:[1,0,1]
    v_pk_fma_f32 v[140:141], v[140:141], v[220:221], s[36:37] op_sel_hi:[1,0,1]
    v_pk_fma_f32 v[142:143], v[142:143], v[220:221], s[36:37] op_sel_hi:[1,0,1]
    v_pk_fma_f32 v[144:145], v[144:145], v[222:223], s[36:37] op_sel_hi:[1,0,1]
    v_pk_fma_f32 v[146:147], v[146:147], v[222:223], s[36:37] op_sel_hi:[1,0,1]
    v_mfma_f32_32x32x16_bf16 v[116:131], v[168:171], v[72:75], v[116:131]
    v_rcp_f32 v132, v132
    v_rcp_f32 v133, v133
    v_rcp_f32 v134, v134
    v_mfma_f32_32x32x16_bf16 v[100:115], v[172:175], v[36:39], v[100:115]
    v_rcp_f32 v135, v135
    v_rcp_f32 v136, v136
    v_rcp_f32 v137, v137
    v_mfma_f32_32x32x16_bf16 v[116:131], v[172:175], v[76:79], v[116:131]
    v_rcp_f32 v138, v138
    v_rcp_f32 v139, v139
    v_rcp_f32 v140, v140
    v_add_u32 v3, 1024, v3
    v_mfma_f32_32x32x16_bf16 v[100:115], v[176:179], v[40:43], v[100:115]
    v_rcp_f32 v141, v141
    v_rcp_f32 v142, v142
    v_add_u32 v4, 1024, v4
    v_mfma_f32_32x32x16_bf16 v[116:131], v[176:179], v[80:83], v[116:131]
    v_rcp_f32 v143, v143
    v_rcp_f32 v144, v144
    v_rcp_f32 v145, v145
    v_rcp_f32 v146, v146
    v_rcp_f32 v147, v147
    s_nop 0
    v_pk_mul_f32 v[132:133], v[132:133], v[148:149]
    v_pk_fma_f32 v[132:133], v[134:135], v[150:151], v[132:133]
    v_pk_fma_f32 v[132:133], v[136:137], v[152:153], v[132:133]
    v_pk_fma_f32 v[132:133], v[138:139], v[154:155], v[132:133]
    v_pk_fma_f32 v[132:133], v[140:141], v[156:157], v[132:133]
    v_pk_fma_f32 v[132:133], v[142:143], v[158:159], v[132:133]
    v_pk_mul_f32 v[144:145], v[144:145], v[160:161]
    v_pk_fma_f32 v[144:145], v[146:147], v[162:163], v[144:145]
    v_add_f32 v132, v132, v133
    v_add_f32 v144, v144, v145
    v_cvt_f64_f32 v[20:21], v132
    v_cvt_f64_f32 v[22:23], v144
    ds_add_f64 v188, v[20:21] offset:25600
    ds_add_f64 v188, v[22:23] offset:25856
    v_and_or_b32 v188, s40, v242, v14
    ds_read2_b64 v[192:195], v188 offset0:0 offset1:32
    s_and_b32 s44, s40, 0xff
    s_cbranch_scc0 L_B0
    s_cmp_gt_u32 s44, 8
    s_cbranch_scc1 L_dh8
    s_cmp_eq_u32 s44, 1
    s_cbranch_scc1 L_B1
    s_cmp_eq_u32 s44, 2
    s_cbranch_scc1 L_B2
    s_cmp_eq_u32 s44, 4
    s_cbranch_scc1 L_B3
    s_cmp_eq_u32 s44, 8
    s_cbranch_scc1 L_B4
    s_branch L_BG
L_dh8:
    s_cmp_eq_u32 s44, 16
    s_cbranch_scc1 L_B5
    s_cmp_eq_u32 s44, 32
    s_cbranch_scc1 L_B6
    s_cmp_eq_u32 s44, 64
    s_cbranch_scc1 L_B7
    s_cmp_eq_u32 s44, 128
    s_cbranch_scc1 L_done
    s_branch L_BG
    .p2align 6
L_B7:
    v_mfma_f32_32x32x16_bf16 v[132:147], v[180:183], v[64:67], 0
    v_exp_f32 v100, v100
    s_add_u32 s34, s34, 1
    v_exp_f32 v101, v101
    ds_read_b128 v[184:187], v3
    v_exp_f32 v102, v102
    ds_read_b32 v11, v4
    v_exp_f32 v103, v103
    s_xor_b32 s52, s52, s53
    v_mfma_f32_32x32x16_bf16 v[132:147], v[164:167], v[48:51], v[132:147]
    v_exp_f32 v104, v104
    v_readlane_b32 s40, v5, s34
    v_exp_f32 v105, v105
    v_exp_f32 v106, v106
    v_exp_f32 v107, v107
    v_mfma_f32_32x32x16_bf16 v[148:163], v[164:167], v[84:87], 0
    v_exp_f32 v108, v108
    v_exp_f32 v109, v109
    v_exp_f32 v110, v110
    v_mfma_f32_32x32x16_bf16 v[132:147], v[168:171], v[52:55], v[132:147]
    v_exp_f32 v111, v111
    v_exp_f32 v112, v112
    v_exp_f32 v113, v113
    v_exp_f32 v114, v114
    v_exp_f32 v115, v115
    s_waitcnt lgkmcnt(2)
    v_pk_fma_f32 v[100:101], v[100:101], v[192:193], s[36:37] op_sel_hi:[1,0,1]
    v_pk_fma_f32 v[102:103], v[102:103], v[192:193], s[36:37] op_sel_hi:[1,0,1]
    v_pk_fma_f32 v[104:105], v[104:105], v[192:193], s[36:37] op_sel_hi:[1,0,1]
    v_pk_fma_f32 v[106:107], v[106:107], v[192:193], s[36:37] op_sel_hi:[1,0,1]
    v_pk_fma_f32 v[108:109], v[108:109], v[192:193], s[36:37] op_sel_hi:[1,0,1]
    v_pk_fma_f32 v[110:111], v[110:111], v[192:193], s[36:37] op_sel_hi:[1,0,1]
    v_pk_fma_f32 v[112:113], v[112:113], v[192:193], s[36:37] op_sel_hi:[1,0,1]
    v_pk_fma_f32 v[114:115], v[114:115], v[194:195], s[36:37] op_sel_hi:[1,0,1]
    v_mfma_f32_32x32x16_bf16 v[148:163], v[168:171], v[88:91], v[148:163]
    v_rcp_f32 v100, v100
    v_rcp_f32 v101, v101
    v_add_u32 v10, s52, v9
    v_rcp_f32 v102, v102
    v_mfma_f32_32x32x16_bf16 v[132:147], v[172:175], v[56:59], v[132:147]
    v_rcp_f32 v103, v103
    v_rcp_f32 v104, v104
    v_rcp_f32 v105, v105
    v_mfma_f32_32x32x16_bf16 v[148:163], v[172:175], v[92:95], v[148:163]
    v_rcp_f32 v106, v106
    v_rcp_f32 v107, v107
    v_rcp_f32 v108, v108
    v_mfma_f32_32x32x16_bf16 v[132:147], v[176:179], v[60:63], v[132:147]
    v_rcp_f32 v109, v109
    v_rcp_f32 v110, v110
    v_mov_b32 v220, v193
    v_mov_b32 v222, v195
    v_mfma_f32_32x32x16_bf16 v[148:163], v[176:179], v[96:99], v[148:163]
    v_rcp_f32 v111, v111
    v_rcp_f32 v112, v112
    v_rcp_f32 v113, v113
    v_rcp_f32 v114, v114
    v_rcp_f32 v115, v115
    s_nop 0
    v_pk_mul_f32 v[100:101], v[100:101], v[116:117]
    s_waitcnt vmcnt(1)
    ds_read_b128 v[180:183], v10
    ds_read_b128 v[164:167], v15 offset:0
    ds_read_b128 v[168:171], v15 offset:32
    ds_read_b128 v[172:175], v15 offset:64
    ds_read_b128 v[176:179], v15 offset:96
    v_pk_fma_f32 v[100:101], v[102:103], v[118:119], v[100:101]
    v_pk_fma_f32 v[100:101], v[104:105], v[120:121], v[100:101]
    v_pk_fma_f32 v[100:101], v[106:107], v[122:123], v[100:101]
    v_pk_fma_f32 v[100:101], v[108:109], v[124:125], v[100:101]
    v_pk_fma_f32 v[100:101], v[110:111], v[126:127], v[100:101]
    v_pk_fma_f32 v[100:101], v[112:113], v[128:129], v[100:101]
    v_pk_mul_f32 v[114:115], v[114:115], v[130:131]
    v_add_f32 v100, v100, v101
    v_add_f32 v114, v114, v115
    v_cvt_f64_f32 v[20:21], v100
    v_cvt_f64_f32 v[22:23], v114
    ds_add_f64 v188, v[20:21] offset:12800
    ds_add_f64 v188, v[22:23] offset:13056
    s_waitcnt lgkmcnt(4)
    v_mfma_f32_32x32x16_bf16 v[100:115], v[180:183], v[44:47], 0
    v_exp_f32 v132, v132
    v_exp_f32 v133, v133
    v_exp_f32 v134, v134
    v_exp_f32 v135, v135
    v_mfma_f32_32x32x16_bf16 v[100:115], v[164:167], v[28:31], v[100:115]
    v_exp_f32 v136, v136
    v_exp_f32 v137, v137
    v_exp_f32 v138, v138
    v_exp_f32 v139, v139
    v_mfma_f32_32x32x16_bf16 v[116:131], v[164:167], v[68:71], 0
    v_exp_f32 v140, v140
    v_exp_f32 v141, v141
    v_exp_f32 v142, v142
    s_waitcnt lgkmcnt(2)
    v_mfma_f32_32x32x16_bf16 v[100:115], v[168:171], v[32:35], v[100:115]
    s_mov_b32 m0, s58
    v_exp_f32 v143, v143
    v_and_or_b32 v12, v184, s38, v6
    buffer_load_dwordx4 v12, s[12:15], 0 offen offset:0 lds
    v_exp_f32 v144, v144
    v_and_or_b32 v12, v185, s38, v6
    buffer_load_dwordx4 v12, s[88:91], 0 offen offset:1056 lds
    v_exp_f32 v145, v145
    v_and_or_b32 v12, v186, s38, v6
    buffer_load_dwordx4 v12, s[92:95], 0 offen offset:2112 lds
    v_exp_f32 v146, v146
    v_and_or_b32 v12, v187, s38, v6
    buffer_load_dwordx4 v12, s[96:99], 0 offen offset:3168 lds
    v_exp_f32 v147, v147
    s_mov_b32 m0, s52
    v_lshl_add_u32 v12, v11, 5, v7
    buffer_load_dwordx4 v12, s[16:19], 0 offen lds
    v_pk_fma_f32 v[132:133], v[132:133], v[220:221], s[36:37] op_sel_hi:[1,0,1]
    v_pk_fma_f32 v[134:135], v[134:135], v[220:221], s[36:37] op_sel_hi:[1,0,1]
    v_pk_fma_f32 v[136:137], v[136:137], v[220:221], s[36:37] op_sel_hi:[1,0,1]
    v_pk_fma_f32 v[138:139], v[138:139], v[220:221], s[36:37] op_sel_hi:[1,0,1]
    v_pk_fma_f32 v[140:141], v[140:141], v[220:221], s[36:37] op_sel_hi:[1,0,1]
    v_pk_fma_f32 v[142:143], v[142:143], v[220:221], s[36:37] op_sel_hi:[1,0,1]
    v_pk_fma_f32 v[144:145], v[144:145], v[220:221], s[36:37] op_sel_hi:[1,0,1]
    v_pk_fma_f32 v[146:147], v[146:147], v[222:223], s[36:37] op_sel_hi:[1,0,1]
    v_mfma_f32_32x32x16_bf16 v[116:131], v[168:171], v[72:75], v[116:131]
    v_rcp_f32 v132, v132
    v_rcp_f32 v133, v133
    v_rcp_f32 v134, v134
    v_mfma_f32_32x32x16_bf16 v[100:115], v[172:175], v[36:39], v[100:115]
    v_rcp_f32 v135, v135
    v_rcp_f32 v136, v136
    v_rcp_f32 v137, v137
    v_mfma_f32_32x32x16_bf16 v[116:131], v[172:175], v[76:79], v[116:131]
    v_rcp_f32 v138, v138
    v_rcp_f32 v139, v139
    v_rcp_f32 v140, v140
    v_add_u32 v3, 1024, v3
    v_mfma_f32_32x32x16_bf16 v[100:115], v[176:179], v[40:43], v[100:115]
    v_rcp_f32 v141, v141
    v_rcp_f32 v142, v142
    v_add_u32 v4, 1024, v4
    v_mfma_f32_32x32x16_bf16 v[116:131], v[176:179], v[80:83], v[116:131]
    v_rcp_f32 v143, v143
    v_rcp_f32 v144, v144
    v_rcp_f32 v145, v145
    v_rcp_f32 v146, v146
    v_rcp_f32 v147, v147
    s_nop 0
    v_pk_mul_f32 v[132:133], v[132:133], v[148:149]
    v_pk_fma_f32 v[132:133], v[134:135], v[150:151], v[132:133]
    v_pk_fma_f32 v[132:133], v[136:137], v[152:153], v[132:133]
    v_pk_fma_f32 v[132:133], v[138:139], v[154:155], v[132:133]
    v_pk_fma_f32 v[132:133], v[140:141], v[156:157], v[132:133]
    v_pk_fma_f32 v[132:133], v[142:143], v[158:159], v[132:133]
    v_pk_fma_f32 v[132:133], v[144:145], v[160:161], v[132:133]
    v_pk_mul_f32 v[146:147], v[146:147], v[162:163]
    v_add_f32 v132, v132, v133
    v_add_f32 v146, v146, v147
    v_cvt_f64_f32 v[20:21], v132
    v_cvt_f64_f32 v[22:23], v146
    ds_add_f64 v188, v[20:21] offset:25600
    ds_add_f64 v188, v[22:23] offset:25856
    v_and_or_b32 v188, s40, v242, v14
    ds_read2_b64 v[192:195], v188 offset0:0 offset1:32
    s_and_b32 s44, s40, 0xff
    s_cbranch_scc0 L_B0
    s_cmp_gt_u32 s44, 8
    s_cbranch_scc1 L_dh9
    s_cmp_eq_u32 s44, 1
    s_cbranch_scc1 L_B1
    s_cmp_eq_u32 s44, 2
    s_cbranch_scc1 L_B2
    s_cmp_eq_u32 s44, 4
    s_cbranch_scc1 L_B3
    s_cmp_eq_u32 s44, 8
    s_cbranch_scc1 L_B4
    s_branch L_BG
L_dh9:
    s_cmp_eq_u32 s44, 16
    s_cbranch_scc1 L_B5
    s_cmp_eq_u32 s44, 32
    s_cbranch_scc1 L_B6
    s_cmp_eq_u32 s44, 64
    s_cbranch_scc1 L_B7
    s_cmp_eq_u32 s44, 128
    s_cbranch_scc1 L_done
    s_branch L_BG
    .p2align 6
L_BG:
    v_mov_b32 v196, v188
    s_bitcmp1_b32 s40, 0
    s_cselect_b32 s44, 256, 0
    v_add_u32 v197, s44, v196
    s_bitcmp1_b32 s40, 1
    s_cselect_b32 s44, 256, 0
    v_add_u32 v198, s44, v197
    s_bitcmp1_b32 s40, 2
    s_cselect_b32 s44, 256, 0
    v_add_u32 v199, s44, v198
    s_bitcmp1_b32 s40, 3
    s_cselect_b32 s44, 256, 0
    v_add_u32 v200, s44, v199
    s_bitcmp1_b32 s40, 4
    s_cselect_b32 s44, 256, 0
    v_add_u32 v201, s44, v200
    s_bitcmp1_b32 s40, 5
    s_cselect_b32 s44, 256, 0
    v_add_u32 v202, s44, v201
    s_bitcmp1_b32 s40, 6
    s_cselect_b32 s44, 256, 0
    v_add_u32 v203, s44, v202
    ds_read_b32 v212, v196 offset:0
    ds_read_b32 v213, v197 offset:0
    ds_read_b32 v214, v198 offset:0
    ds_read_b32 v215, v199 offset:0
    ds_read_b32 v216, v200 offset:0
    ds_read_b32 v217, v201 offset:0
    ds_read_b32 v218, v202 offset:0
    ds_read_b32 v219, v203 offset:0
    s_waitcnt lgkmcnt(0)
    v_cndmask_b32 v204, 0, v212, s[76:77]
    v_cndmask_b32 v212, v212, 1.0, s[76:77]
    v_cndmask_b32 v205, 0, v213, s[76:77]
    v_cndmask_b32 v213, v213, 1.0, s[76:77]
    v_cndmask_b32 v206, 0, v214, s[76:77]
    v_cndmask_b32 v214, v214, 1.0, s[76:77]
    v_cndmask_b32 v207, 0, v215, s[76:77]
    v_cndmask_b32 v215, v215, 1.0, s[76:77]
    v_cndmask_b32 v208, 0, v216, s[76:77]
    v_cndmask_b32 v216, v216, 1.0, s[76:77]
    v_cndmask_b32 v209, 0, v217, s[76:77]
    v_cndmask_b32 v217, v217, 1.0, s[76:77]
    v_cndmask_b32 v210, 0, v218, s[76:77]
    v_cndmask_b32 v218, v218, 1.0, s[76:77]
    v_cndmask_b32 v211, 0, v219, s[76:77]
    v_cndmask_b32 v219, v219, 1.0, s[76:77]
    v_add_f32 v100, v100, v204
    v_add_f32 v101, v101, v204
    v_add_f32 v102, v102, v205
    v_add_f32 v103, v103, v205
    v_add_f32 v104, v104, v206
    v_add_f32 v105, v105, v206
    v_add_f32 v106, v106, v207
    v_add_f32 v107, v107, v207
    v_add_f32 v108, v108, v208
    v_add_f32 v109, v109, v208
    v_add_f32 v110, v110, v209
    v_add_f32 v111, v111, v209
    v_add_f32 v112, v112, v210
    v_add_f32 v113, v113, v210
    v_add_f32 v114, v114, v211
    v_add_f32 v115, v115, v211
    v_mfma_f32_32x32x16_bf16 v[132:147], v[180:183], v[64:67], 0
    v_exp_f32 v100, v100
    s_add_u32 s34, s34, 1
    v_exp_f32 v101, v101
    ds_read_b128 v[184:187], v3
    v_exp_f32 v102, v102
    ds_read_b32 v11, v4
    v_exp_f32 v103, v103
    s_xor_b32 s52, s52, s53
    v_mfma_f32_32x32x16_bf16 v[132:147], v[164:167], v[48:51], v[132:147]
    v_exp_f32 v104, v104
    v_readlane_b32 s40, v5, s34
    v_exp_f32 v105, v105
    v_exp_f32 v106, v106
    v_exp_f32 v107, v107
    v_mfma_f32_32x32x16_bf16 v[148:163], v[164:167], v[84:87], 0
    v_exp_f32 v108, v108
    v_exp_f32 v109, v109
    v_exp_f32 v110, v110
    v_mfma_f32_32x32x16_bf16 v[132:147], v[168:171], v[52:55], v[132:147]
    v_exp_f32 v111, v111
    v_exp_f32 v112, v112
    v_exp_f32 v113, v113
    v_exp_f32 v114, v114
    v_exp_f32 v115, v115
    s_waitcnt lgkmcnt(2)
    v_fma_f32 v100, v100, v212, 1.0
    v_fma_f32 v101, v101, v212, 1.0
    v_fma_f32 v102, v102, v213, 1.0
    v_fma_f32 v103, v103, v213, 1.0
    v_fma_f32 v104, v104, v214, 1.0
    v_fma_f32 v105, v105, v214, 1.0
    v_fma_f32 v106, v106, v215, 1.0
    v_fma_f32 v107, v107, v215, 1.0
    v_fma_f32 v108, v108, v216, 1.0
    v_fma_f32 v109, v109, v216, 1.0
    v_fma_f32 v110, v110, v217, 1.0
    v_fma_f32 v111, v111, v217, 1.0
    v_fma_f32 v112, v112, v218, 1.0
    v_fma_f32 v113, v113, v218, 1.0
    v_fma_f32 v114, v114, v219, 1.0
    v_fma_f32 v115, v115, v219, 1.0
    v_mfma_f32_32x32x16_bf16 v[148:163], v[168:171], v[88:91], v[148:163]
    v_rcp_f32 v100, v100
    v_rcp_f32 v101, v101
    v_add_u32 v10, s52, v9
    v_rcp_f32 v102, v102
    v_mfma_f32_32x32x16_bf16 v[132:147], v[172:175], v[56:59], v[132:147]
    v_rcp_f32 v103, v103
    v_rcp_f32 v104, v104
    v_rcp_f32 v105, v105
    v_mfma_f32_32x32x16_bf16 v[148:163], v[172:175], v[92:95], v[148:163]
    v_rcp_f32 v106, v106
    v_rcp_f32 v107, v107
    v_rcp_f32 v108, v108
    v_mfma_f32_32x32x16_bf16 v[132:147], v[176:179], v[60:63], v[132:147]
    v_rcp_f32 v109, v109
    v_rcp_f32 v110, v110
    v_mfma_f32_32x32x16_bf16 v[148:163], v[176:179], v[96:99], v[148:163]
    v_rcp_f32 v111, v111
    v_rcp_f32 v112, v112
    v_rcp_f32 v113, v113
    v_rcp_f32 v114, v114
    v_rcp_f32 v115, v115
    s_nop 0
    v_pk_mul_f32 v[100:101], v[100:101], v[116:117]
    s_waitcnt vmcnt(1)
    ds_read_b128 v[180:183], v10
    ds_read_b128 v[164:167], v15 offset:0
    ds_read_b128 v[168:171], v15 offset:32
    ds_read_b128 v[172:175], v15 offset:64
    ds_read_b128 v[176:179], v15 offset:96
    v_add_f32 v100, v100, v101
    v_cvt_f64_f32 v[20:21], v100
    ds_add_f64 v196, v[20:21] offset:12800
    v_pk_mul_f32 v[102:103], v[102:103], v[118:119]
    v_add_f32 v102, v102, v103
    v_cvt_f64_f32 v[22:23], v102
    ds_add_f64 v197, v[22:23] offset:12800
    v_pk_mul_f32 v[104:105], v[104:105], v[120:121]
    v_add_f32 v104, v104, v105
    v_cvt_f64_f32 v[24:25], v104
    ds_add_f64 v198, v[24:25] offset:12800
    v_pk_mul_f32 v[106:107], v[106:107], v[122:123]
    v_add_f32 v106, v106, v107
    v_cvt_f64_f32 v[26:27], v106
    ds_add_f64 v199, v[26:27] offset:12800
    v_pk_mul_f32 v[108:109], v[108:109], v[124:125]
    v_add_f32 v108, v108, v109
    v_cvt_f64_f32 v[20:21], v108
    ds_add_f64 v200, v[20:21] offset:12800
    v_pk_mul_f32 v[110:111], v[110:111], v[126:127]
    v_add_f32 v110, v110, v111
    v_cvt_f64_f32 v[22:23], v110
    ds_add_f64 v201, v[22:23] offset:12800
    v_pk_mul_f32 v[112:113], v[112:113], v[128:129]
    v_add_f32 v112, v112, v113
    v_cvt_f64_f32 v[24:25], v112
    ds_add_f64 v202, v[24:25] offset:12800
    v_pk_mul_f32 v[114:115], v[114:115], v[130:131]
    v_add_f32 v114, v114, v115
    v_cvt_f64_f32 v[26:27], v114
    ds_add_f64 v203, v[26:27] offset:12800
    ds_read_b32 v212, v196 offset:4
    ds_read_b32 v213, v197 offset:4
    ds_read_b32 v214, v198 offset:4
    ds_read_b32 v215, v199 offset:4
    ds_read_b32 v216, v200 offset:4
    ds_read_b32 v217, v201 offset:4
    ds_read_b32 v218, v202 offset:4
    ds_read_b32 v219, v203 offset:4
    s_waitcnt lgkmcnt(0)
    v_cndmask_b32 v204, 0, v212, s[76:77]
    v_cndmask_b32 v212, v212, 1.0, s[76:77]
    v_cndmask_b32 v205, 0, v213, s[76:77]
    v_cndmask_b32 v213, v213, 1.0, s[76:77]
    v_cndmask_b32 v206, 0, v214, s[76:77]
    v_cndmask_b32 v214, v214, 1.0, s[76:77]
    v_cndmask_b32 v207, 0, v215, s[76:77]
    v_cndmask_b32 v215, v215, 1.0, s[76:77]
    v_cndmask_b32 v208, 0, v216, s[76:77]
    v_cndmask_b32 v216, v216, 1.0, s[76:77]
    v_cndmask_b32 v209, 0, v217, s[76:77]
    v_cndmask_b32 v217, v217, 1.0, s[76:77]
    v_cndmask_b32 v210, 0, v218, s[76:77]
    v_cndmask_b32 v218, v218, 1.0, s[76:77]
    v_cndmask_b32 v211, 0, v219, s[76:77]
    v_cndmask_b32 v219, v219, 1.0, s[76:77]
    v_add_f32 v132, v132, v204
    v_add_f32 v133, v133, v204
    v_add_f32 v134, v134, v205
    v_add_f32 v135, v135, v205
    v_add_f32 v136, v136, v206
    v_add_f32 v137, v137, v206
    v_add_f32 v138, v138, v207
    v_add_f32 v139, v139, v207
    v_add_f32 v140, v140, v208
    v_add_f32 v141, v141, v208
    v_add_f32 v142, v142, v209
    v_add_f32 v143, v143, v209
    v_add_f32 v144, v144, v210
    v_add_f32 v145, v145, v210
    v_add_f32 v146, v146, v211
    v_add_f32 v147, v147, v211
    s_waitcnt lgkmcnt(10)
    v_mfma_f32_32x32x16_bf16 v[100:115], v[180:183], v[44:47], 0
    v_exp_f32 v132, v132
    v_exp_f32 v133, v133
    v_exp_f32 v134, v134
    v_exp_f32 v135, v135
    v_mfma_f32_32x32x16_bf16 v[100:115], v[164:167], v[28:31], v[100:115]
    v_exp_f32 v136, v136
    v_exp_f32 v137, v137
    v_exp_f32 v138, v138
    v_exp_f32 v139, v139
    v_mfma_f32_32x32x16_bf16 v[116:131], v[164:167], v[68:71], 0
    v_exp_f32 v140, v140
    v_exp_f32 v141, v141
    v_exp_f32 v142, v142
    s_waitcnt lgkmcnt(8)
    v_mfma_f32_32x32x16_bf16 v[100:115], v[168:171], v[32:35], v[100:115]
    s_mov_b32 m0, s58
    v_exp_f32 v143, v143
    v_and_or_b32 v12, v184, s38, v6
    buffer_load_dwordx4 v12, s[12:15], 0 offen offset:0 lds
    v_exp_f32 v144, v144
    v_and_or_b32 v12, v185, s38, v6
    buffer_load_dwordx4 v12, s[88:91], 0 offen offset:1056 lds
    v_exp_f32 v145, v145
    v_and_or_b32 v12, v186, s38, v6
    buffer_load_dwordx4 v12, s[92:95], 0 offen offset:2112 lds
    v_exp_f32 v146, v146
    v_and_or_b32 v12, v187, s38, v6
    buffer_load_dwordx4 v12, s[96:99], 0 offen offset:3168 lds
    v_exp_f32 v147, v147
    s_mov_b32 m0, s52
    v_lshl_add_u32 v12, v11, 5, v7
    buffer_load_dwordx4 v12, s[16:19], 0 offen lds
    v_fma_f32 v132, v132, v212, 1.0
    v_fma_f32 v133, v133, v212, 1.0
    v_fma_f32 v134, v134, v213, 1.0
    v_fma_f32 v135, v135, v213, 1.0
    v_fma_f32 v136, v136, v214, 1.0
    v_fma_f32 v137, v137, v214, 1.0
    v_fma_f32 v138, v138, v215, 1.0
    v_fma_f32 v139, v139, v215, 1.0
    v_fma_f32 v140, v140, v216, 1.0
    v_fma_f32 v141, v141, v216, 1.0
    v_fma_f32 v142, v142, v217, 1.0
    v_fma_f32 v143, v143, v217, 1.0
    v_fma_f32 v144, v144, v218, 1.0
    v_fma_f32 v145, v145, v218, 1.0
    v_fma_f32 v146, v146, v219, 1.0
    v_fma_f32 v147, v147, v219, 1.0
    v_mfma_f32_32x32x16_bf16 v[116:131], v[168:171], v[72:75], v[116:131]
    v_rcp_f32 v132, v132
    v_rcp_f32 v133, v133
    v_rcp_f32 v134, v134
    v_mfma_f32_32x32x16_bf16 v[100:115], v[172:175], v[36:39], v[100:115]
    v_rcp_f32 v135, v135
    v_rcp_f32 v136, v136
    v_rcp_f32 v137, v137
    v_mfma_f32_32x32x16_bf16 v[116:131], v[172:175], v[76:79], v[116:131]
    v_rcp_f32 v138, v138
    v_rcp_f32 v139, v139
    v_rcp_f32 v140, v140
    v_add_u32 v3, 1024, v3
    v_mfma_f32_32x32x16_bf16 v[100:115], v[176:179], v[40:43], v[100:115]
    v_rcp_f32 v141, v141
    v_rcp_f32 v142, v142
    v_add_u32 v4, 1024, v4
    v_mfma_f32_32x32x16_bf16 v[116:131], v[176:179], v[80:83], v[116:131]
    v_rcp_f32 v143, v143
    v_rcp_f32 v144, v144
    v_rcp_f32 v145, v145
    v_rcp_f32 v146, v146
    v_rcp_f32 v147, v147
    s_nop 0
    v_pk_mul_f32 v[132:133], v[132:133], v[148:149]
    v_add_f32 v132, v132, v133
    v_cvt_f64_f32 v[20:21], v132
    ds_add_f64 v196, v[20:21] offset:25600
    v_pk_mul_f32 v[134:135], v[134:135], v[150:151]
    v_add_f32 v134, v134, v135
    v_cvt_f64_f32 v[22:23], v134
    ds_add_f64 v197, v[22:23] offset:25600
    v_pk_mul_f32 v[136:137], v[136:137], v[152:153]
    v_add_f32 v136, v136, v137
    v_cvt_f64_f32 v[24:25], v136
    ds_add_f64 v198, v[24:25] offset:25600
    v_pk_mul_f32 v[138:139], v[138:139], v[154:155]
    v_add_f32 v138, v138, v139
    v_cvt_f64_f32 v[26:27], v138
    ds_add_f64 v199, v[26:27] offset:25600
    v_pk_mul_f32 v[140:141], v[140:141], v[156:157]
    v_add_f32 v140, v140, v141
    v_cvt_f64_f32 v[20:21], v140
    ds_add_f64 v200, v[20:21] offset:25600
    v_pk_mul_f32 v[142:143], v[142:143], v[158:159]
    v_add_f32 v142, v142, v143
    v_cvt_f64_f32 v[22:23], v142
    ds_add_f64 v201, v[22:23] offset:25600
    v_pk_mul_f32 v[144:145], v[144:145], v[160:161]
    v_add_f32 v144, v144, v145
    v_cvt_f64_f32 v[24:25], v144
    ds_add_f64 v202, v[24:25] offset:25600
    v_pk_mul_f32 v[146:147], v[146:147], v[162:163]
    v_add_f32 v146, v146, v147
    v_cvt_f64_f32 v[26:27], v146
    ds_add_f64 v203, v[26:27] offset:25600
    v_and_or_b32 v188, s40, v242, v14
    ds_read2_b64 v[192:195], v188 offset0:0 offset1:32
    s_cmp_eq_u32 s59, 0
    s_cbranch_scc1 L_dn10
    s_bitcmp1_b32 s40, 7
    s_cbranch_scc1 L_done
    s_branch L_BG
L_dn10:
    s_and_b32 s44, s40, 0xff
    s_cbranch_scc0 L_B0
    s_cmp_gt_u32 s44, 8
    s_cbranch_scc1 L_dh10
    s_cmp_eq_u32 s44, 1
    s_cbranch_scc1 L_B1
    s_cmp_eq_u32 s44, 2
    s_cbranch_scc1 L_B2
    s_cmp_eq_u32 s44, 4
    s_cbranch_scc1 L_B3
    s_cmp_eq_u32 s44, 8
    s_cbranch_scc1 L_B4
    s_branch L_BG
L_dh10:
    s_cmp_eq_u32 s44, 16
    s_cbranch_scc1 L_B5
    s_cmp_eq_u32 s44, 32
    s_cbranch_scc1 L_B6
    s_cmp_eq_u32 s44, 64
    s_cbranch_scc1 L_B7
    s_cmp_eq_u32 s44, 128
    s_cbranch_scc1 L_done
    s_branch L_BG
L_done:
L_k2_after:
    s_waitcnt vmcnt(0) lgkmcnt(0)
    s_barrier
    s_add_u32 s29, s29, s30
    s_cmp_lg_u32 s42, 0
    s_cbranch_scc1 L_k2_init
L_k2_epi:
    v_cmp_gt_u32 vcc, 392, v0
    s_and_saveexec_b64 s[44:45], vcc
    s_cbranch_execz L_k2_end
    v_lshrrev_b32 v18, 3, v0
    v_and_b32 v19, 7, v0
    v_bfe_u32 v16, v0, 2, 1
    v_mul_u32_u24 v16, 12800, v16
    v_lshl_add_u32 v16, v18, 8, v16
    v_and_b32 v17, 3, v0
    v_lshl_add_u32 v16, v17, 6, v16
    ds_read_b128 v[120:123], v16 offset:51968
    ds_read_b128 v[124:127], v16 offset:51984
    ds_read_b128 v[128:131], v16 offset:52000
    ds_read_b128 v[132:135], v16 offset:52016
    v_lshlrev_b32 v18, 8, v18
    v_add_u32 v18, s2, v18
    v_lshlrev_b32 v18, 7, v18
    v_lshl_add_u32 v18, v19, 4, v18
    s_mov_b32 s46, 0xbfb8aa3b
    s_waitcnt lgkmcnt(0)
    v_cvt_f32_f64 v100, v[120:121]
    v_cvt_f32_f64 v101, v[122:123]
    v_cvt_f32_f64 v102, v[124:125]
    v_cvt_f32_f64 v103, v[126:127]
    v_cvt_f32_f64 v104, v[128:129]
    v_cvt_f32_f64 v105, v[130:131]
    v_cvt_f32_f64 v106, v[132:133]
    v_cvt_f32_f64 v107, v[134:135]
    v_mul_f32 v108, s46, v100
    v_mul_f32 v109, s46, v101
    v_mul_f32 v110, s46, v102
    v_mul_f32 v111, s46, v103
    v_mul_f32 v112, s46, v104
    v_mul_f32 v113, s46, v105
    v_mul_f32 v114, s46, v106
    v_mul_f32 v115, s46, v107
    v_exp_f32 v108, v108
    v_exp_f32 v109, v109
    v_exp_f32 v110, v110
    v_exp_f32 v111, v111
    v_exp_f32 v112, v112
    v_exp_f32 v113, v113
    v_exp_f32 v114, v114
    v_exp_f32 v115, v115
    v_add_f32 v108, 1.0, v108
    v_add_f32 v109, 1.0, v109
    v_add_f32 v110, 1.0, v110
    v_add_f32 v111, 1.0, v111
    v_add_f32 v112, 1.0, v112
    v_add_f32 v113, 1.0, v113
    v_add_f32 v114, 1.0, v114
    v_add_f32 v115, 1.0, v115
    v_rcp_f32 v108, v108
    v_rcp_f32 v109, v109
    v_rcp_f32 v110, v110
    v_rcp_f32 v111, v111
    v_rcp_f32 v112, v112
    v_rcp_f32 v113, v113
    v_rcp_f32 v114, v114
    v_rcp_f32 v115, v115
    v_mul_f32 v100, v100, v108
    v_mul_f32 v101, v101, v109
    v_mul_f32 v102, v102, v110
    v_mul_f32 v103, v103, v111
    v_mul_f32 v104, v104, v112
    v_mul_f32 v105, v105, v113
    v_mul_f32 v106, v106, v114
    v_mul_f32 v107, v107, v115
    v_cvt_pk_bf16_f32 v116, v100, v101
    v_cvt_pk_bf16_f32 v117, v102, v103
    v_cvt_pk_bf16_f32 v118, v104, v105
    v_cvt_pk_bf16_f32 v119, v106, v107
    buffer_store_dwordx4 v[116:119], v18, s[24:27], 0 offen
L_k2_end:
    s_endpgm
.section .rodata,"a"
.p2align 6
.amdhsa_kernel bin_kernel
  .amdhsa_next_free_vgpr 48
  .amdhsa_next_free_sgpr 40
  .amdhsa_accum_offset 48
  .amdhsa_group_segment_fixed_size 0
  .amdhsa_kernarg_size 80
  .amdhsa_user_sgpr_count 2
  .amdhsa_user_sgpr_kernarg_segment_ptr 1
  .amdhsa_system_sgpr_workgroup_id_x 1
.end_amdhsa_kernel
.p2align 6
.amdhsa_kernel main_kernel
  .amdhsa_next_free_vgpr 256
  .amdhsa_next_free_sgpr 102
  .amdhsa_accum_offset 256
  .amdhsa_group_segment_fixed_size 0
  .amdhsa_kernarg_size 80
  .amdhsa_user_sgpr_count 2
  .amdhsa_user_sgpr_kernarg_segment_ptr 1
  .amdhsa_system_sgpr_workgroup_id_x 1
.end_amdhsa_kernel
```
